```python
import torch

def _softmax(x, axis=-1):
    return torch.softmax(x, dim=axis)
def _gelu(x):
    return torch.nn.functional.gelu(x, approximate="tanh")
def _silu(x):
    return torch.nn.functional.silu(x)
def _sigmoid(x):
    return torch.sigmoid(x)
def _layernorm(x, axis=-1, eps=1e-5):
    m = x.mean(dim=axis, keepdim=True)
    v = x.var(dim=axis, keepdim=True, unbiased=False)
    return (x - m) / torch.sqrt(v + eps)
def _scatter_add(tgt, idx, src, axis=0):
    return tgt.clone().index_add_(axis, idx, src)
def _segment_sum(src, seg, n):
    out = torch.zeros((n,) + src.shape[1:], dtype=src.dtype)
    return out.index_add_(0, seg, src)
def _pad(x, pw):
    flat = tuple(v for pair in reversed(pw) for v in pair)
    return torch.nn.functional.pad(x, flat)

kernel_name = 'gated_mix__grouped_kv_mqa__moe_arch_mod__prompt'

def setup_inputs():

    _w = (lambda a: (lambda t: t.to(torch.bfloat16) if t.is_floating_point() else t)(torch.as_tensor(a)))
    def _A_setup():
        B, S, D, H = 1, 2048, 576, 32
        Dh = D // H
        return {
            "x": _w((lambda *s: torch.randn(*s, dtype=torch.bfloat16) * 0.05)(B, S, D)),
            "wq": _w((lambda *s: torch.randn(*s, dtype=torch.bfloat16) * 0.8)(D, H * Dh)),
            "wk": _w((lambda *s: torch.randn(*s, dtype=torch.bfloat16) * 0.8)(D, Dh)),
            "wv": _w((lambda *s: torch.randn(*s, dtype=torch.bfloat16) * 0.2)(D, Dh)),
            "wo": _w((lambda *s: torch.randn(*s, dtype=torch.bfloat16) * 0.2)(H * Dh, D)),
        }
    _A_in = _A_setup()

    def _B_setup():
        B, S, D, F, C = 1, 2048, 576, 4608, 2
        return {
            "x": _w((lambda *s: torch.randn(*s, dtype=torch.bfloat16) * 0.05)(B, S, D)),
            "w_r": _w((lambda *s: torch.randn(*s, dtype=torch.bfloat16) * 1.6)(D)),
            "w_gate": _w((lambda *s: torch.randn(*s, dtype=torch.bfloat16) * 0.1)(D, F)),
            "w_up": _w((lambda *s: torch.randn(*s, dtype=torch.bfloat16) * 0.1)(D, F)),
            "w_down": _w((lambda *s: torch.randn(*s, dtype=torch.bfloat16) * 0.1)(F, D)),
        }
    _B_in = _B_setup()

    return {
        "A_x": _A_in["x"],
        "A_wq": _A_in["wq"],
        "A_wk": _A_in["wk"],
        "A_wv": _A_in["wv"],
        "A_wo": _A_in["wo"],
        "B_x": _B_in["x"],
        "B_w_r": _B_in["w_r"],
        "B_w_gate": _B_in["w_gate"],
        "B_w_up": _B_in["w_up"],
        "B_w_down": _B_in["w_down"],
        "gate_w": _w((lambda *s: torch.randn(*s, dtype=torch.bfloat16) * 0.05)(576) * 16.0),
    }

def reference(A_x, A_wq, A_wk, A_wv, A_wo, B_x, B_w_r, B_w_gate, B_w_up, B_w_down, gate_w):
    def _A_ref(x, wq, wk, wv, wo):
        B, S, D = x.shape
        H = 32
        Dh = D // H
        q = (lambda x, *d: x.permute(*d))((x @ wq).reshape(B, S, H, Dh), 0, 2, 1, 3)
        k = x @ wk
        v = x @ wv
        scores = torch.einsum("bhqd,bkd->bhqk", q, k) * (Dh ** -0.5)
        p = _softmax(scores, axis=-1)
        o = torch.einsum("bhqk,bkd->bhqd", p, v)
        return (lambda x, *d: x.permute(*d))(o, 0, 2, 1, 3).reshape(B, S, H * Dh) @ wo

    def _B_ref(x, w_r, w_gate, w_up, w_down):
        B, S, D = x.shape
        C = 2
        r = x @ w_r
        idx = torch.argsort(-r, axis=-1)[:, :C]
        idx_e = (lambda x, n, axis: torch.repeat_interleave(x, n, dim=axis))(idx.reshape(B, C, 1), D, axis=2)
        x_sel = (lambda x, i, axis: torch.take_along_dim(x, i, dim=axis))(x, idx_e, axis=1)
        g = _silu(x_sel @ w_gate)
        u = x_sel @ w_up
        y = (g * u) @ w_down
        r_sel = _sigmoid((lambda x, i, axis: torch.take_along_dim(x, i, dim=axis))(r, idx, axis=1))
        y = y * r_sel.reshape(B, C, 1)
        b_off = (torch.arange(B) * S).reshape(B, 1)
        flat_idx = (idx + b_off).reshape(B * C)
        zero = (x * 0.0).reshape(B * S, D)
        upd = _scatter_add(zero, flat_idx, y.reshape(B * C, D), axis=0)
        return x + upd.reshape(B, S, D)

    x = A_x
    g = _sigmoid((x * gate_w).sum(-1, keepdims=True))
    a = _A_ref(x, A_wq, A_wk, A_wv, A_wo)
    b = _B_ref(x, B_w_r, B_w_gate, B_w_up, B_w_down)
    return g * a + (1 - g) * b
```

```asm
; @launch grid=(256,1,1) block=(512,1,1) lds=163840
.amdgcn_target "amdgcn-amd-amdhsa--gfx950"
.text
.globl gated_mix__grouped_kv_mqa__moe_arch_mod__prompt_kernel
.p2align 8
.type gated_mix__grouped_kv_mqa__moe_arch_mod__prompt_kernel,@function
gated_mix__grouped_kv_mqa__moe_arch_mod__prompt_kernel:
    s_cmp_ge_u32 s2, 256
    s_cbranch_scc1 L_end
    s_load_dwordx2 s[32:33], s[0:1], 0
    s_load_dwordx2 s[64:65], s[0:1], 80
    s_load_dwordx2 s[68:69], s[0:1], 48
    s_load_dwordx2 s[36:37], s[0:1], 8
    s_load_dwordx4 s[40:43], s[0:1], 16
    s_load_dwordx2 s[80:81], s[0:1], 104
    s_load_dwordx2 s[76:77], s[0:1], 96
    v_lshrrev_b32 v6, 6, v0
    v_and_b32 v1, 63, v0
    v_readfirstlane_b32 s84, v6
    v_and_b32 v2, 15, v0
    v_bfe_u32 v3, v0, 4, 2
    v_lshlrev_b32 v5, 4, v1
    s_and_b32 s90, s2, 7
    s_lshr_b32 s92, s2, 3
    s_and_b32 s93, s92, 1
    s_lshl1_add_u32 s85, s90, s93
    s_lshr_b32 s86, s2, 4
    s_mul_i32 s89, s90, 24
    s_add_u32 s89, s89, s92
    s_sub_u32 s89, s89, 8
    s_lshl3_add_u32 s87, s85, s84
    s_lshr_b32 s48, s84, 2
    s_and_b32 s50, s84, 3
    s_and_b32 s49, s86, 1
    s_cmp_lt_u32 s86, 4
    s_cselect_b32 s49, s49, 0
    s_mov_b32 s34, 2359296
    s_mov_b32 s35, 0x20000
    s_mov_b32 s66, 1152
    s_mov_b32 s67, 0x20000
    s_mov_b32 s70, 1152
    s_mov_b32 s71, 0x20000
    s_waitcnt lgkmcnt(0)
    s_cmp_eq_u32 s48, s49
    s_cbranch_scc0 L_roundB_1
    s_setprio 3
    v_lshrrev_b32 v6, 3, v1
    s_mul_i32 s90, s87, 18432
    v_and_b32 v7, 6, v6
    v_and_b32 v8, 7, v1
    s_mul_i32 s91, s50, 18432
    v_xor_b32 v7, v7, v8
    v_mul_u32_u24 v6, 1152, v6
    v_lshl_add_u32 v9, v7, 4, v6
    v_add_u32 v10, 9216, v9
    s_bitcmp1_b32 s86, 1
    s_cbranch_scc1 L_xrev_9
    s_mov_b32 m0, s91
    s_nop 0
    buffer_load_dwordx4 v9, s[32:35], s90 offen lds
    s_add_u32 m0, m0, 1024
    s_mov_b32 s82, 268435456
    buffer_load_dwordx4 v10, s[32:35], s90 offen lds
    s_add_u32 m0, m0, 896
    s_mov_b32 s83, 0x20000
    buffer_load_dwordx4 v9, s[32:35], s90 offen offset:128 lds
    s_add_u32 m0, m0, 1024
    s_mov_b32 s78, 256
    buffer_load_dwordx4 v10, s[32:35], s90 offen offset:128 lds
    s_add_u32 m0, m0, 896
    s_mov_b32 s79, 0x20000
    buffer_load_dwordx4 v9, s[32:35], s90 offen offset:256 lds
    s_add_u32 m0, m0, 1024
    s_load_dwordx2 s[44:45], s[0:1], 32
    buffer_load_dwordx4 v10, s[32:35], s90 offen offset:256 lds
    s_add_u32 m0, m0, 896
    s_load_dwordx2 s[72:73], s[0:1], 88
    buffer_load_dwordx4 v9, s[32:35], s90 offen offset:384 lds
    s_add_u32 m0, m0, 1024
    s_load_dwordx2 s[52:53], s[0:1], 56
    buffer_load_dwordx4 v10, s[32:35], s90 offen offset:384 lds
    s_add_u32 m0, m0, 896
    s_load_dwordx2 s[56:57], s[0:1], 64
    buffer_load_dwordx4 v9, s[32:35], s90 offen offset:512 lds
    s_add_u32 m0, m0, 1024
    s_load_dwordx2 s[60:61], s[0:1], 72
    buffer_load_dwordx4 v10, s[32:35], s90 offen offset:512 lds
    s_add_u32 m0, m0, 896
    s_mov_b32 s46, 663552
    buffer_load_dwordx4 v9, s[32:35], s90 offen offset:640 lds
    s_add_u32 m0, m0, 1024
    s_mov_b32 s47, 0x20000
    buffer_load_dwordx4 v10, s[32:35], s90 offen offset:640 lds
    s_add_u32 m0, m0, 896
    s_mov_b32 s74, 2359296
    buffer_load_dwordx4 v9, s[32:35], s90 offen offset:768 lds
    s_add_u32 m0, m0, 1024
    s_mov_b32 s75, 0x20000
    buffer_load_dwordx4 v10, s[32:35], s90 offen offset:768 lds
    s_add_u32 m0, m0, 896
    s_mov_b32 s54, 5308416
    buffer_load_dwordx4 v9, s[32:35], s90 offen offset:896 lds
    s_add_u32 m0, m0, 1024
    s_mov_b32 s55, 0x20000
    buffer_load_dwordx4 v10, s[32:35], s90 offen offset:896 lds
    s_add_u32 m0, m0, 896
    s_mov_b32 s58, 5308416
    buffer_load_dwordx4 v9, s[32:35], s90 offen offset:1024 lds
    s_add_u32 m0, m0, 1024
    s_mov_b32 s59, 0x20000
    buffer_load_dwordx4 v10, s[32:35], s90 offen offset:1024 lds
    s_mov_b32 s62, 5308416
    s_mov_b32 s63, 0x20000
    s_branch L_xdone_10
L_xrev_9:
    s_add_u32 m0, s91, 15360
    s_nop 0
    buffer_load_dwordx4 v9, s[32:35], s90 offen offset:1024 lds
    s_add_u32 m0, m0, 1024
    s_mov_b32 s82, 268435456
    buffer_load_dwordx4 v10, s[32:35], s90 offen offset:1024 lds
    s_sub_u32 m0, m0, 2944
    s_mov_b32 s83, 0x20000
    buffer_load_dwordx4 v9, s[32:35], s90 offen offset:896 lds
    s_add_u32 m0, m0, 1024
    s_mov_b32 s78, 256
    buffer_load_dwordx4 v10, s[32:35], s90 offen offset:896 lds
    s_sub_u32 m0, m0, 2944
    s_mov_b32 s79, 0x20000
    buffer_load_dwordx4 v9, s[32:35], s90 offen offset:768 lds
    s_add_u32 m0, m0, 1024
    s_load_dwordx2 s[44:45], s[0:1], 32
    buffer_load_dwordx4 v10, s[32:35], s90 offen offset:768 lds
    s_sub_u32 m0, m0, 2944
    s_load_dwordx2 s[72:73], s[0:1], 88
    buffer_load_dwordx4 v9, s[32:35], s90 offen offset:640 lds
    s_add_u32 m0, m0, 1024
    s_load_dwordx2 s[52:53], s[0:1], 56
    buffer_load_dwordx4 v10, s[32:35], s90 offen offset:640 lds
    s_sub_u32 m0, m0, 2944
    s_load_dwordx2 s[56:57], s[0:1], 64
    buffer_load_dwordx4 v9, s[32:35], s90 offen offset:512 lds
    s_add_u32 m0, m0, 1024
    s_load_dwordx2 s[60:61], s[0:1], 72
    buffer_load_dwordx4 v10, s[32:35], s90 offen offset:512 lds
    s_sub_u32 m0, m0, 2944
    s_mov_b32 s46, 663552
    buffer_load_dwordx4 v9, s[32:35], s90 offen offset:384 lds
    s_add_u32 m0, m0, 1024
    s_mov_b32 s47, 0x20000
    buffer_load_dwordx4 v10, s[32:35], s90 offen offset:384 lds
    s_sub_u32 m0, m0, 2944
    s_mov_b32 s74, 2359296
    buffer_load_dwordx4 v9, s[32:35], s90 offen offset:256 lds
    s_add_u32 m0, m0, 1024
    s_mov_b32 s75, 0x20000
    buffer_load_dwordx4 v10, s[32:35], s90 offen offset:256 lds
    s_sub_u32 m0, m0, 2944
    s_mov_b32 s54, 5308416
    buffer_load_dwordx4 v9, s[32:35], s90 offen offset:128 lds
    s_add_u32 m0, m0, 1024
    s_mov_b32 s55, 0x20000
    buffer_load_dwordx4 v10, s[32:35], s90 offen offset:128 lds
    s_sub_u32 m0, m0, 2944
    s_mov_b32 s58, 5308416
    buffer_load_dwordx4 v9, s[32:35], s90 offen lds
    s_add_u32 m0, m0, 1024
    s_mov_b32 s59, 0x20000
    buffer_load_dwordx4 v10, s[32:35], s90 offen lds
    s_mov_b32 s62, 5308416
    s_mov_b32 s63, 0x20000
L_xdone_10:
    s_or_b32 s92, s2, s84
    s_cbranch_scc1 L_nononce_11
    s_memrealtime s[90:91]
    s_mov_b32 s78, 256
    s_mov_b32 s79, 0x20000
    v_mov_b32 v7, 0
    s_waitcnt lgkmcnt(0)
    s_or_b32 s90, s90, 1
    v_mov_b32 v6, s90
    v_cmp_eq_u32 vcc, 0, v1
    s_nop 0
    s_and_saveexec_b64 s[96:97], vcc
    s_cbranch_execz L_skip_12
    buffer_store_dword v6, v7, s[76:79], 0 offen sc1
L_skip_12:
    s_mov_b64 exec, s[96:97]
L_nononce_11:
    s_mov_b32 s28, 147456
    v_and_b32 v14, 7, v2
    v_and_b32 v15, 6, v14
    v_xor_b32 v12, v15, v3
    v_lshrrev_b32 v15, 3, v2
    v_lshlrev_b32 v15, 10, v15
    v_lshl_add_u32 v15, v14, 7, v15
    s_mul_i32 s95, s50, 18432
    v_add_u32 v15, s95, v15
    v_xor_b32 v13, 4, v12
    v_lshl_add_u32 v12, v12, 4, v15
    v_lshl_add_u32 v13, v13, 4, v15
    v_bfe_u32 v6, v1, 2, 2
    v_and_b32 v7, 3, v1
    v_and_b32 v8, 1, v3
    v_lshl_add_u32 v9, v3, 3, v6
    v_lshl_add_u32 v8, v8, 2, v9
    v_lshlrev_b32 v10, 3, v7
    v_xor_b32 v11, 4, v8
    v_lshl_add_u32 v39, v8, 5, v10
    v_lshl_add_u32 v40, v11, 5, v10
    v_add_u32 v39, 129024, v39
    v_add_u32 v40, 129024, v40
    v_lshlrev_b32 v9, 4, v9
    v_and_b32 v41, 8, v10
    v_add3_u32 v41, v41, v9, s28
    v_mul_u32_u24 v8, 96, v8
    v_mul_u32_u24 v11, 96, v11
    v_add_u32 v8, 73728, v8
    v_add_u32 v11, 73728, v11
    v_add_u32 v240, v8, v10
    v_add_u32 v241, v11, v10
    v_and_b32 v7, 1, v7
    v_mul_u32_u24 v7, 24, v7
    v_add_u32 v7, 64, v7
    v_add_u32 v242, v8, v7
    v_add_u32 v243, v11, v7
    v_mul_u32_u24 v6, 43, v1
    v_lshrrev_b32 v6, 8, v6
    v_mul_u32_u24 v7, 6, v6
    v_sub_u32 v7, v1, v7
    s_and_b32 s90, s84, 1
    s_lshl_b32 s90, s90, 2
    v_lshlrev_b32 v7, 4, v7
    v_xor_b32 v6, s90, v6
    s_movk_i32 s90, 1152
    v_lshrrev_b32 v8, 2, v6
    v_and_b32 v9, 3, v6
    v_lshl_add_u32 v8, v8, 3, v9
    v_mad_u32_u24 v244, v8, s90, v7
    v_lshrrev_b32 v8, 1, v6
    v_and_b32 v9, 1, v6
    v_mad_u32_u24 v8, v8, 18, v9
    v_mad_u32_u24 v245, v8, s90, v7
    v_mul_u32_u24 v249, 1152, v2
    v_lshl_add_u32 v248, v3, 4, v249
    v_and_b32 v6, 31, v1
    v_lshrrev_b32 v8, 5, v1
    v_lshlrev_b32 v7, 4, v6
    v_min_u32 v6, 19, v6
    v_mul_u32_u24 v8, 320, v8
    v_lshl_add_u32 v8, v6, 4, v8
    s_lshl_b32 s90, s48, 15
    s_lshl_b32 s91, s48, 12
    s_mul_i32 s92, s48, 40960
    s_add_u32 s91, s91, 65536
    s_add_u32 s92, s92, 73728
    v_add_u32 v33, s90, v5
    v_add_u32 v34, s91, v7
    v_add_u32 v35, s92, v8
    v_mov_b32 v32, 0xdddddddd
    s_mul_i32 s90, s87, 18432
    s_mul_i32 s91, s86, 72
    s_add_u32 s51, s90, s91
    v_and_b32 v6, 1, v1
    v_mov_b32 v7, 0x01000c0c
    v_cmp_eq_u32 vcc, 0, v6
    v_mov_b32 v8, 0x0c0c0100
    v_mov_b32 v9, 0x03020c0c
    v_cndmask_b32 v250, v7, v8, vcc
    v_mov_b32 v8, 0x0c0c0302
    v_cndmask_b32 v251, v9, v8, vcc
    v_lshlrev_b32 v6, 9, v3
    v_lshl_add_u32 v6, v2, 5, v6
    s_lshl2_add_u32 s90, s84, 157952
    v_add_u32 v252, s90, v6
    v_lshlrev_b32 v7, 2, v1
    v_add_u32 v7, 161536, v7
    v_lshrrev_b32 v6, 2, v1
    v_and_b32 v8, 1, v1
    v_lshl_add_u32 v6, v6, 1, v8
    v_bfe_u32 v8, v1, 1, 1
    v_lshlrev_b32 v8, 8, v8
    v_cmp_gt_u32 vcc, 48, v1
    v_lshl_add_u32 v6, v6, 2, v8
    v_add_u32 v6, 157184, v6
    v_cndmask_b32 v253, v7, v6, vcc
    v_lshlrev_b32 v6, 3, v3
    v_add_u32 v6, s84, v6
    v_lshlrev_b32 v7, 6, v6
    v_cmp_gt_u32 vcc, 18, v6
    v_lshl_add_u32 v7, v2, 2, v7
    v_mov_b32 v8, 268435456
    v_cndmask_b32 v254, v8, v7, vcc
    s_mul_i32 s90, s50, 3072
    s_lshl_b32 s91, s48, 15
    s_add_u32 s90, s90, s91
    v_add_u32 v246, s90, v5
    v_xor_b32 v247, 0x8000, v246
    s_lshl4_add_u32 s90, s87, s86
    s_lshl_b32 s22, s90, 10
    s_add_u32 s22, s22, 524288
    s_lshl_b32 s26, s87, 11
    s_add_u32 s26, s26, 2621440
    s_lshr_b32 s92, s86, 3
    s_lshl_b32 s92, s92, 10
    s_add_u32 s23, s26, s92
    s_and_b32 s93, s86, 1
    s_lshl_b32 s93, s93, 9
    s_add_u32 s23, s23, s93
    s_bfe_u32 s92, s86, 0x20001
    s_lshl_b32 s92, s92, 6
    s_add_u32 s23, s23, s92
    s_lshl_b32 s25, s87, 14
    s_add_u32 s25, s25, 524288
    s_lshl_b32 s27, s85, 11
    s_add_u32 s27, s27, 262144
    s_lshl_b32 s90, s86, 7
    s_add_u32 s24, s27, s90
    v_lshlrev_b32 v6, 8, v3
    v_cmp_gt_u32 vcc, 32, v1
    v_lshl_add_u32 v6, v2, 2, v6
    v_mov_b32 v7, 268435456
    v_cndmask_b32 v238, v7, v6, vcc
    s_waitcnt vmcnt(0) lgkmcnt(0)
    ds_read_b128 v[64:67], v12 offset:0
    ds_read_b128 v[68:71], v13 offset:0
    ds_read_b128 v[72:75], v12 offset:2048
    ds_read_b128 v[76:79], v13 offset:2048
    ds_read_b128 v[80:83], v12 offset:4096
    ds_read_b128 v[84:87], v13 offset:4096
    ds_read_b128 v[88:91], v12 offset:6144
    ds_read_b128 v[92:95], v13 offset:6144
    ds_read_b128 v[96:99], v12 offset:8192
    ds_read_b128 v[100:103], v13 offset:8192
    ds_read_b128 v[104:107], v12 offset:10240
    ds_read_b128 v[108:111], v13 offset:10240
    ds_read_b128 v[112:115], v12 offset:12288
    ds_read_b128 v[116:119], v13 offset:12288
    s_waitcnt lgkmcnt(8)
    ds_read_b128 v[120:123], v12 offset:14336
    ds_read_b128 v[124:127], v13 offset:14336
    ds_read_b128 v[128:131], v12 offset:16384
    ds_read_b128 v[132:135], v13 offset:16384
    s_waitcnt lgkmcnt(0)
    s_barrier
    s_cmp_lt_u32 s86, 4
    s_cbranch_scc0 L_noprod_6
    s_cmp_ge_u32 s86, 2
    s_cbranch_scc1 L_roleV_3
    s_mul_i32 s90, s87, 144
    s_add_u32 s90, s90, 159744
    v_mov_b32 v12, 0
    v_mov_b32 v13, 0
    v_mov_b32 v14, 0
    v_mov_b32 v15, 0
    v_cmp_gt_u32 vcc, 9, v1
    s_nop 0
    s_and_saveexec_b64 s[96:97], vcc
    s_cbranch_execz L_skip_13
    buffer_store_dwordx4 v[12:15], v5, s[80:83], s90 offen sc1
L_skip_13:
    s_mov_b64 exec, s[96:97]
    ds_read_b64_tr_b16 v[188:189], v39 offset:0
    ds_read_b64_tr_b16 v[190:191], v40 offset:0
    ds_read_b64_tr_b16 v[192:193], v41 offset:0
    ds_read_b64_tr_b16 v[194:195], v41 offset:64
    ds_read_b64_tr_b16 v[196:197], v39 offset:1024
    ds_read_b64_tr_b16 v[198:199], v40 offset:1024
    ds_read_b64_tr_b16 v[200:201], v41 offset:512
    ds_read_b64_tr_b16 v[202:203], v41 offset:576
    ds_read_b64_tr_b16 v[204:205], v39 offset:2048
    ds_read_b64_tr_b16 v[206:207], v40 offset:2048
    ds_read_b64_tr_b16 v[208:209], v41 offset:1024
    ds_read_b64_tr_b16 v[210:211], v41 offset:1088
    s_waitcnt lgkmcnt(8)
    v_mfma_f32_16x16x32_bf16 v[140:143], v[188:191], v[64:67], 0
    ds_read_b64_tr_b16 v[212:213], v39 offset:3072
    ds_read_b64_tr_b16 v[214:215], v40 offset:3072
    v_mfma_f32_16x16x32_bf16 v[144:147], v[192:195], v[64:67], 0
    ds_read_b64_tr_b16 v[216:217], v41 offset:1536
    ds_read_b64_tr_b16 v[218:219], v41 offset:1600
    s_waitcnt lgkmcnt(8)
    v_mfma_f32_16x16x32_bf16 v[140:143], v[196:199], v[68:71], v[140:143]
    ds_read_b64_tr_b16 v[188:189], v39 offset:4096
    ds_read_b64_tr_b16 v[190:191], v40 offset:4096
    v_mfma_f32_16x16x32_bf16 v[144:147], v[200:203], v[68:71], v[144:147]
    ds_read_b64_tr_b16 v[192:193], v41 offset:2048
    ds_read_b64_tr_b16 v[194:195], v41 offset:2112
    s_waitcnt lgkmcnt(8)
    v_mfma_f32_16x16x32_bf16 v[140:143], v[204:207], v[72:75], v[140:143]
    ds_read_b64_tr_b16 v[196:197], v39 offset:5120
    ds_read_b64_tr_b16 v[198:199], v40 offset:5120
    v_mfma_f32_16x16x32_bf16 v[144:147], v[208:211], v[72:75], v[144:147]
    ds_read_b64_tr_b16 v[200:201], v41 offset:2560
    ds_read_b64_tr_b16 v[202:203], v41 offset:2624
    s_waitcnt lgkmcnt(8)
    v_mfma_f32_16x16x32_bf16 v[140:143], v[212:215], v[76:79], v[140:143]
    ds_read_b64_tr_b16 v[204:205], v39 offset:6144
    ds_read_b64_tr_b16 v[206:207], v40 offset:6144
    v_mfma_f32_16x16x32_bf16 v[144:147], v[216:219], v[76:79], v[144:147]
    ds_read_b64_tr_b16 v[208:209], v41 offset:3072
    ds_read_b64_tr_b16 v[210:211], v41 offset:3136
    s_waitcnt lgkmcnt(8)
    v_mfma_f32_16x16x32_bf16 v[140:143], v[188:191], v[80:83], v[140:143]
    ds_read_b64_tr_b16 v[212:213], v39 offset:7168
    ds_read_b64_tr_b16 v[214:215], v40 offset:7168
    v_mfma_f32_16x16x32_bf16 v[144:147], v[192:195], v[80:83], v[144:147]
    ds_read_b64_tr_b16 v[216:217], v41 offset:3584
    ds_read_b64_tr_b16 v[218:219], v41 offset:3648
    s_waitcnt lgkmcnt(8)
    v_mfma_f32_16x16x32_bf16 v[140:143], v[196:199], v[84:87], v[140:143]
    ds_read_b64_tr_b16 v[188:189], v39 offset:8192
    ds_read_b64_tr_b16 v[190:191], v40 offset:8192
    v_mfma_f32_16x16x32_bf16 v[144:147], v[200:203], v[84:87], v[144:147]
    ds_read_b64_tr_b16 v[192:193], v41 offset:4096
    ds_read_b64_tr_b16 v[194:195], v41 offset:4160
    s_waitcnt lgkmcnt(8)
    v_mfma_f32_16x16x32_bf16 v[140:143], v[204:207], v[88:91], v[140:143]
    ds_read_b64_tr_b16 v[196:197], v39 offset:9216
    ds_read_b64_tr_b16 v[198:199], v40 offset:9216
    v_mfma_f32_16x16x32_bf16 v[144:147], v[208:211], v[88:91], v[144:147]
    ds_read_b64_tr_b16 v[200:201], v41 offset:4608
    ds_read_b64_tr_b16 v[202:203], v41 offset:4672
    s_waitcnt lgkmcnt(8)
    v_mfma_f32_16x16x32_bf16 v[140:143], v[212:215], v[92:95], v[140:143]
    ds_read_b64_tr_b16 v[204:205], v39 offset:10240
    ds_read_b64_tr_b16 v[206:207], v40 offset:10240
    v_mfma_f32_16x16x32_bf16 v[144:147], v[216:219], v[92:95], v[144:147]
    ds_read_b64_tr_b16 v[208:209], v41 offset:5120
    ds_read_b64_tr_b16 v[210:211], v41 offset:5184
    s_waitcnt lgkmcnt(8)
    v_mfma_f32_16x16x32_bf16 v[140:143], v[188:191], v[96:99], v[140:143]
    ds_read_b64_tr_b16 v[212:213], v39 offset:11264
    ds_read_b64_tr_b16 v[214:215], v40 offset:11264
    v_mfma_f32_16x16x32_bf16 v[144:147], v[192:195], v[96:99], v[144:147]
    ds_read_b64_tr_b16 v[216:217], v41 offset:5632
    ds_read_b64_tr_b16 v[218:219], v41 offset:5696
    s_waitcnt lgkmcnt(8)
    v_mfma_f32_16x16x32_bf16 v[140:143], v[196:199], v[100:103], v[140:143]
    ds_read_b64_tr_b16 v[188:189], v39 offset:12288
    ds_read_b64_tr_b16 v[190:191], v40 offset:12288
    v_mfma_f32_16x16x32_bf16 v[144:147], v[200:203], v[100:103], v[144:147]
    ds_read_b64_tr_b16 v[192:193], v41 offset:6144
    ds_read_b64_tr_b16 v[194:195], v41 offset:6208
    s_waitcnt lgkmcnt(8)
    v_mfma_f32_16x16x32_bf16 v[140:143], v[204:207], v[104:107], v[140:143]
    ds_read_b64_tr_b16 v[196:197], v39 offset:13312
    ds_read_b64_tr_b16 v[198:199], v40 offset:13312
    v_mfma_f32_16x16x32_bf16 v[144:147], v[208:211], v[104:107], v[144:147]
    ds_read_b64_tr_b16 v[200:201], v41 offset:6656
    ds_read_b64_tr_b16 v[202:203], v41 offset:6720
    s_waitcnt lgkmcnt(8)
    v_mfma_f32_16x16x32_bf16 v[140:143], v[212:215], v[108:111], v[140:143]
    ds_read_b64_tr_b16 v[204:205], v39 offset:14336
    ds_read_b64_tr_b16 v[206:207], v40 offset:14336
    v_mfma_f32_16x16x32_bf16 v[144:147], v[216:219], v[108:111], v[144:147]
    ds_read_b64_tr_b16 v[208:209], v41 offset:7168
    ds_read_b64_tr_b16 v[210:211], v41 offset:7232
    s_waitcnt lgkmcnt(8)
    v_mfma_f32_16x16x32_bf16 v[140:143], v[188:191], v[112:115], v[140:143]
    ds_read_b64_tr_b16 v[212:213], v39 offset:15360
    ds_read_b64_tr_b16 v[214:215], v40 offset:15360
    v_mfma_f32_16x16x32_bf16 v[144:147], v[192:195], v[112:115], v[144:147]
    ds_read_b64_tr_b16 v[216:217], v41 offset:7680
    ds_read_b64_tr_b16 v[218:219], v41 offset:7744
    s_waitcnt lgkmcnt(8)
    v_mfma_f32_16x16x32_bf16 v[140:143], v[196:199], v[116:119], v[140:143]
    ds_read_b64_tr_b16 v[188:189], v39 offset:16384
    ds_read_b64_tr_b16 v[190:191], v40 offset:16384
    v_mfma_f32_16x16x32_bf16 v[144:147], v[200:203], v[116:119], v[144:147]
    ds_read_b64_tr_b16 v[192:193], v41 offset:8192
    ds_read_b64_tr_b16 v[194:195], v41 offset:8256
    s_waitcnt lgkmcnt(8)
    v_mfma_f32_16x16x32_bf16 v[140:143], v[204:207], v[120:123], v[140:143]
    ds_read_b64_tr_b16 v[196:197], v39 offset:17408
    ds_read_b64_tr_b16 v[198:199], v40 offset:17408
    v_mfma_f32_16x16x32_bf16 v[144:147], v[208:211], v[120:123], v[144:147]
    ds_read_b64_tr_b16 v[200:201], v41 offset:8704
    ds_read_b64_tr_b16 v[202:203], v41 offset:8768
    s_waitcnt lgkmcnt(8)
    v_mfma_f32_16x16x32_bf16 v[140:143], v[212:215], v[124:127], v[140:143]
    v_mfma_f32_16x16x32_bf16 v[144:147], v[216:219], v[124:127], v[144:147]
    s_waitcnt lgkmcnt(4)
    v_mfma_f32_16x16x32_bf16 v[140:143], v[188:191], v[128:131], v[140:143]
    v_mfma_f32_16x16x32_bf16 v[144:147], v[192:195], v[128:131], v[144:147]
    s_waitcnt lgkmcnt(0)
    v_mfma_f32_16x16x32_bf16 v[140:143], v[196:199], v[132:135], v[140:143]
    v_mfma_f32_16x16x32_bf16 v[144:147], v[200:203], v[132:135], v[144:147]
    s_and_b32 s90, s87, 1
    s_lshr_b32 s91, s87, 1
    v_lshl_add_u32 v8, s90, 4, v2
    v_lshrrev_b32 v6, 1, v3
    v_and_b32 v7, 1, v3
    v_lshlrev_b32 v8, 4, v8
    v_lshl_add_u32 v6, v6, 9, v8
    v_lshl_add_u32 v6, v7, 3, v6
    s_lshl_b32 s92, s91, 10
    v_cvt_pk_bf16_f32 v10, v140, v141
    v_cvt_pk_bf16_f32 v11, v142, v143
    buffer_store_dwordx2 v[10:11], v6, s[80:83], s92 offen sc1
    s_lshr_b32 s92, s91, 2
    s_lshl_b32 s92, s92, 9
    s_and_b32 s93, s91, 3
    s_lshl2_add_u32 s92, s93, s92
    s_add_u32 s92, s92, 65536
    v_cvt_pk_bf16_f32 v12, v144, v145
    v_cmp_gt_u32 vcc, 16, v1
    s_nop 0
    s_and_saveexec_b64 s[96:97], vcc
    s_cbranch_execz L_skip_14
    buffer_store_dword v12, v8, s[80:83], s92 offen sc1
L_skip_14:
    s_mov_b64 exec, s[96:97]
    v_ashrrev_i32 v6, 31, v144
    s_lshl_b32 s90, s87, 4
    v_or_b32 v6, 0x80000000, v6
    s_sub_u32 s90, 2047, s90
    v_xor_b32 v6, v6, v144
    v_sub_u32 v7, s90, v2
    v_and_b32 v6, 0xfffff800, v6
    v_or_b32 v10, v6, v7
    v_mov_b32 v11, 0
    s_nop 0
    v_min_u32_dpp v14, v10, v10 row_ror:8 row_mask:0xf bank_mask:0xf
    v_max_u32_dpp v13, v11, v11 row_ror:8 row_mask:0xf bank_mask:0xf
    v_max_u32_dpp v10, v10, v10 row_ror:8 row_mask:0xf bank_mask:0xf
    v_max_u32 v11, v13, v14
    s_nop 0
    v_min_u32_dpp v14, v10, v10 row_ror:4 row_mask:0xf bank_mask:0xf
    v_max_u32_dpp v13, v11, v11 row_ror:4 row_mask:0xf bank_mask:0xf
    v_max_u32_dpp v10, v10, v10 row_ror:4 row_mask:0xf bank_mask:0xf
    v_max_u32 v11, v13, v14
    s_nop 0
    v_min_u32_dpp v14, v10, v10 row_ror:2 row_mask:0xf bank_mask:0xf
    v_max_u32_dpp v13, v11, v11 row_ror:2 row_mask:0xf bank_mask:0xf
    v_max_u32_dpp v10, v10, v10 row_ror:2 row_mask:0xf bank_mask:0xf
    v_max_u32 v11, v13, v14
    s_nop 0
    v_min_u32_dpp v14, v10, v10 row_ror:1 row_mask:0xf bank_mask:0xf
    v_max_u32_dpp v13, v11, v11 row_ror:1 row_mask:0xf bank_mask:0xf
    v_max_u32_dpp v10, v10, v10 row_ror:1 row_mask:0xf bank_mask:0xf
    v_max_u32 v11, v13, v14
    s_lshl_b32 s90, s87, 3
    s_add_u32 s90, s90, 155648
    v_mov_b32 v7, 0
    v_cmp_eq_u32 vcc, 16, v1
    s_nop 0
    s_and_saveexec_b64 s[96:97], vcc
    s_cbranch_execz L_skip_15
    buffer_store_dwordx2 v[10:11], v7, s[80:83], s90 offen sc1
L_skip_15:
    s_mov_b64 exec, s[96:97]
    s_branch L_pub_4
L_roleV_3:
    ds_read_b64_tr_b16 v[188:189], v39 offset:0
    ds_read_b64_tr_b16 v[190:191], v40 offset:0
    ds_read_b64_tr_b16 v[192:193], v41 offset:0
    ds_read_b64_tr_b16 v[194:195], v41 offset:64
    ds_read_b64_tr_b16 v[196:197], v39 offset:1024
    ds_read_b64_tr_b16 v[198:199], v40 offset:1024
    ds_read_b64_tr_b16 v[200:201], v41 offset:512
    ds_read_b64_tr_b16 v[202:203], v41 offset:576
    ds_read_b64_tr_b16 v[204:205], v39 offset:2048
    ds_read_b64_tr_b16 v[206:207], v40 offset:2048
    ds_read_b64_tr_b16 v[208:209], v41 offset:1024
    ds_read_b64_tr_b16 v[210:211], v41 offset:1088
    s_waitcnt lgkmcnt(8)
    v_mfma_f32_16x16x32_bf16 v[140:143], v[64:67], v[188:191], 0
    ds_read_b64_tr_b16 v[212:213], v39 offset:3072
    ds_read_b64_tr_b16 v[214:215], v40 offset:3072
    v_mfma_f32_16x16x32_bf16 v[144:147], v[64:67], v[192:195], 0
    ds_read_b64_tr_b16 v[216:217], v41 offset:1536
    ds_read_b64_tr_b16 v[218:219], v41 offset:1600
    s_waitcnt lgkmcnt(8)
    v_mfma_f32_16x16x32_bf16 v[140:143], v[68:71], v[196:199], v[140:143]
    ds_read_b64_tr_b16 v[188:189], v39 offset:4096
    ds_read_b64_tr_b16 v[190:191], v40 offset:4096
    v_mfma_f32_16x16x32_bf16 v[144:147], v[68:71], v[200:203], v[144:147]
    ds_read_b64_tr_b16 v[192:193], v41 offset:2048
    ds_read_b64_tr_b16 v[194:195], v41 offset:2112
    s_waitcnt lgkmcnt(8)
    v_mfma_f32_16x16x32_bf16 v[140:143], v[72:75], v[204:207], v[140:143]
    ds_read_b64_tr_b16 v[196:197], v39 offset:5120
    ds_read_b64_tr_b16 v[198:199], v40 offset:5120
    v_mfma_f32_16x16x32_bf16 v[144:147], v[72:75], v[208:211], v[144:147]
    ds_read_b64_tr_b16 v[200:201], v41 offset:2560
    ds_read_b64_tr_b16 v[202:203], v41 offset:2624
    s_waitcnt lgkmcnt(8)
    v_mfma_f32_16x16x32_bf16 v[140:143], v[76:79], v[212:215], v[140:143]
    ds_read_b64_tr_b16 v[204:205], v39 offset:6144
    ds_read_b64_tr_b16 v[206:207], v40 offset:6144
    v_mfma_f32_16x16x32_bf16 v[144:147], v[76:79], v[216:219], v[144:147]
    ds_read_b64_tr_b16 v[208:209], v41 offset:3072
    ds_read_b64_tr_b16 v[210:211], v41 offset:3136
    s_waitcnt lgkmcnt(8)
    v_mfma_f32_16x16x32_bf16 v[140:143], v[80:83], v[188:191], v[140:143]
    ds_read_b64_tr_b16 v[212:213], v39 offset:7168
    ds_read_b64_tr_b16 v[214:215], v40 offset:7168
    v_mfma_f32_16x16x32_bf16 v[144:147], v[80:83], v[192:195], v[144:147]
    ds_read_b64_tr_b16 v[216:217], v41 offset:3584
    ds_read_b64_tr_b16 v[218:219], v41 offset:3648
    s_waitcnt lgkmcnt(8)
    v_mfma_f32_16x16x32_bf16 v[140:143], v[84:87], v[196:199], v[140:143]
    ds_read_b64_tr_b16 v[188:189], v39 offset:8192
    ds_read_b64_tr_b16 v[190:191], v40 offset:8192
    v_mfma_f32_16x16x32_bf16 v[144:147], v[84:87], v[200:203], v[144:147]
    ds_read_b64_tr_b16 v[192:193], v41 offset:4096
    ds_read_b64_tr_b16 v[194:195], v41 offset:4160
    s_waitcnt lgkmcnt(8)
    v_mfma_f32_16x16x32_bf16 v[140:143], v[88:91], v[204:207], v[140:143]
    ds_read_b64_tr_b16 v[196:197], v39 offset:9216
    ds_read_b64_tr_b16 v[198:199], v40 offset:9216
    v_mfma_f32_16x16x32_bf16 v[144:147], v[88:91], v[208:211], v[144:147]
    ds_read_b64_tr_b16 v[200:201], v41 offset:4608
    ds_read_b64_tr_b16 v[202:203], v41 offset:4672
    s_waitcnt lgkmcnt(8)
    v_mfma_f32_16x16x32_bf16 v[140:143], v[92:95], v[212:215], v[140:143]
    ds_read_b64_tr_b16 v[204:205], v39 offset:10240
    ds_read_b64_tr_b16 v[206:207], v40 offset:10240
    v_mfma_f32_16x16x32_bf16 v[144:147], v[92:95], v[216:219], v[144:147]
    ds_read_b64_tr_b16 v[208:209], v41 offset:5120
    ds_read_b64_tr_b16 v[210:211], v41 offset:5184
    s_waitcnt lgkmcnt(8)
    v_mfma_f32_16x16x32_bf16 v[140:143], v[96:99], v[188:191], v[140:143]
    ds_read_b64_tr_b16 v[212:213], v39 offset:11264
    ds_read_b64_tr_b16 v[214:215], v40 offset:11264
    v_mfma_f32_16x16x32_bf16 v[144:147], v[96:99], v[192:195], v[144:147]
    ds_read_b64_tr_b16 v[216:217], v41 offset:5632
    ds_read_b64_tr_b16 v[218:219], v41 offset:5696
    s_waitcnt lgkmcnt(8)
    v_mfma_f32_16x16x32_bf16 v[140:143], v[100:103], v[196:199], v[140:143]
    ds_read_b64_tr_b16 v[188:189], v39 offset:12288
    ds_read_b64_tr_b16 v[190:191], v40 offset:12288
    v_mfma_f32_16x16x32_bf16 v[144:147], v[100:103], v[200:203], v[144:147]
    ds_read_b64_tr_b16 v[192:193], v41 offset:6144
    ds_read_b64_tr_b16 v[194:195], v41 offset:6208
    s_waitcnt lgkmcnt(8)
    v_mfma_f32_16x16x32_bf16 v[140:143], v[104:107], v[204:207], v[140:143]
    ds_read_b64_tr_b16 v[196:197], v39 offset:13312
    ds_read_b64_tr_b16 v[198:199], v40 offset:13312
    v_mfma_f32_16x16x32_bf16 v[144:147], v[104:107], v[208:211], v[144:147]
    ds_read_b64_tr_b16 v[200:201], v41 offset:6656
    ds_read_b64_tr_b16 v[202:203], v41 offset:6720
    s_waitcnt lgkmcnt(8)
    v_mfma_f32_16x16x32_bf16 v[140:143], v[108:111], v[212:215], v[140:143]
    ds_read_b64_tr_b16 v[204:205], v39 offset:14336
    ds_read_b64_tr_b16 v[206:207], v40 offset:14336
    v_mfma_f32_16x16x32_bf16 v[144:147], v[108:111], v[216:219], v[144:147]
    ds_read_b64_tr_b16 v[208:209], v41 offset:7168
    ds_read_b64_tr_b16 v[210:211], v41 offset:7232
    s_waitcnt lgkmcnt(8)
    v_mfma_f32_16x16x32_bf16 v[140:143], v[112:115], v[188:191], v[140:143]
    ds_read_b64_tr_b16 v[212:213], v39 offset:15360
    ds_read_b64_tr_b16 v[214:215], v40 offset:15360
    v_mfma_f32_16x16x32_bf16 v[144:147], v[112:115], v[192:195], v[144:147]
    ds_read_b64_tr_b16 v[216:217], v41 offset:7680
    ds_read_b64_tr_b16 v[218:219], v41 offset:7744
    s_waitcnt lgkmcnt(8)
    v_mfma_f32_16x16x32_bf16 v[140:143], v[116:119], v[196:199], v[140:143]
    ds_read_b64_tr_b16 v[188:189], v39 offset:16384
    ds_read_b64_tr_b16 v[190:191], v40 offset:16384
    v_mfma_f32_16x16x32_bf16 v[144:147], v[116:119], v[200:203], v[144:147]
    ds_read_b64_tr_b16 v[192:193], v41 offset:8192
    ds_read_b64_tr_b16 v[194:195], v41 offset:8256
    s_waitcnt lgkmcnt(8)
    v_mfma_f32_16x16x32_bf16 v[140:143], v[120:123], v[204:207], v[140:143]
    ds_read_b64_tr_b16 v[196:197], v39 offset:17408
    ds_read_b64_tr_b16 v[198:199], v40 offset:17408
    v_mfma_f32_16x16x32_bf16 v[144:147], v[120:123], v[208:211], v[144:147]
    ds_read_b64_tr_b16 v[200:201], v41 offset:8704
    ds_read_b64_tr_b16 v[202:203], v41 offset:8768
    s_waitcnt lgkmcnt(8)
    v_mfma_f32_16x16x32_bf16 v[140:143], v[124:127], v[212:215], v[140:143]
    v_mfma_f32_16x16x32_bf16 v[144:147], v[124:127], v[216:219], v[144:147]
    s_waitcnt lgkmcnt(4)
    v_mfma_f32_16x16x32_bf16 v[140:143], v[128:131], v[188:191], v[140:143]
    v_mfma_f32_16x16x32_bf16 v[144:147], v[128:131], v[192:195], v[144:147]
    s_waitcnt lgkmcnt(0)
    v_mfma_f32_16x16x32_bf16 v[140:143], v[132:135], v[196:199], v[140:143]
    v_mfma_f32_16x16x32_bf16 v[144:147], v[132:135], v[200:203], v[144:147]
    v_lshrrev_b32 v6, 1, v3
    v_and_b32 v7, 1, v3
    v_mul_u32_u24 v6, 320, v6
    s_mul_i32 s92, s87, 640
    v_lshl_add_u32 v6, v7, 3, v6
    s_add_u32 s92, s92, 73728
    v_lshl_add_u32 v6, v2, 4, v6
    v_cvt_pk_bf16_f32 v10, v140, v141
    v_cvt_pk_bf16_f32 v11, v142, v143
    buffer_store_dwordx2 v[10:11], v6, s[80:83], s92 offen sc1
    v_cvt_pk_bf16_f32 v12, v144, v145
    v_cvt_pk_bf16_f32 v13, v146, v147
    v_cmp_eq_u32 vcc, 2, v2
    v_mov_b32 v14, 0x3f803f80
    v_mov_b32 v15, 0
    v_cndmask_b32 v14, v15, v14, vcc
    v_cmp_gt_u32 vcc, 2, v2
    s_nop 1
    v_cndmask_b32 v12, v14, v12, vcc
    v_cndmask_b32 v13, v14, v13, vcc
    v_cmp_gt_u32 vcc, 4, v2
    s_nop 0
    s_and_saveexec_b64 s[96:97], vcc
    s_cbranch_execz L_skip_16
    buffer_store_dwordx2 v[12:13], v6, s[80:83], s92 offen offset:256 sc1
L_skip_16:
    s_mov_b64 exec, s[96:97]
L_pub_4:
    v_mov_b32 v7, 0
    buffer_load_dword v6, v7, s[76:79], 0 offen sc1
    s_waitcnt vmcnt(0)
    v_readfirstlane_b32 s88, v6
    s_nop 0
    s_cmp_lg_u32 s88, 0
    s_cbranch_scc1 L_have_nonce_17
    v_mov_b32 v7, 0
    s_mov_b32 s3, 400000
L_nonce_18:
    buffer_load_dword v6, v7, s[76:79], 0 offen sc1
    s_waitcnt vmcnt(0)
    v_readfirstlane_b32 s88, v6
    s_nop 0
    s_cmp_lg_u32 s88, 0
    s_cbranch_scc1 L_nonce_done_19
    s_sub_u32 s3, s3, 1
    s_cbranch_scc1 L_nonce_done_19
    s_branch L_nonce_18
L_nonce_done_19:
L_have_nonce_17:
    s_lshl4_add_u32 s90, s86, s85
    s_lshl_b32 s90, s90, 7
    s_add_u32 s90, s90, 196608
    v_mov_b32 v6, s88
    v_mov_b32 v7, 0
    s_barrier
    s_cmp_lg_u32 s50, 0
    s_cbranch_scc1 L_noflag_20
    buffer_store_dword v6, v7, s[80:83], s90 offen sc1
L_noflag_20:
    s_setprio 0
    s_barrier
    s_branch L_qproj_2
L_noprod_6:
    s_setprio 0
    s_branch L_qproj_2
L_roundB_1:
    s_mov_b32 s38, 663552
    s_mov_b32 s39, 0x20000
    s_cmp_lt_u32 s86, 4
    s_cbranch_scc0 L_nokv_5
    s_cmp_ge_u32 s86, 2
    s_cselect_b32 s40, s42, s40
    s_cselect_b32 s41, s43, s41
    s_mov_b32 s42, 20736
    s_mov_b32 s43, 0x20000
    v_lshrrev_b32 v6, 1, v1
    v_bfe_u32 v7, v6, 3, 1
    v_lshlrev_b32 v7, 2, v7
    v_xor_b32 v6, v6, v7
    v_and_b32 v7, 1, v1
    v_lshlrev_b32 v7, 4, v7
    v_mad_u32_u24 v45, v6, 36, v7
    s_mul_i32 s90, s50, 1152
    s_lshl_b32 s93, s50, 10
    s_add_u32 m0, s93, 129024
    s_nop 0
    buffer_load_dwordx4 v45, s[40:43], s90 offen lds
    s_add_u32 m0, m0, 4096
    s_add_u32 s90, s90, 4608
    buffer_load_dwordx4 v45, s[40:43], s90 offen lds
    s_add_u32 m0, m0, 4096
    s_add_u32 s90, s90, 4608
    buffer_load_dwordx4 v45, s[40:43], s90 offen lds
    s_add_u32 m0, m0, 4096
    s_add_u32 s90, s90, 4608
    buffer_load_dwordx4 v45, s[40:43], s90 offen lds
    s_cmp_ge_u32 s50, 2
    s_cbranch_scc1 L_skipround_21
    s_add_u32 m0, m0, 4096
    s_add_u32 s90, s90, 4608
    buffer_load_dwordx4 v45, s[40:43], s90 offen lds
L_skipround_21:
    v_lshl_add_u32 v11, s50, 6, v1
    v_lshlrev_b32 v12, 1, v11
    buffer_load_ushort v56, v12, s[64:67], 0 offen offset:0
    buffer_load_ushort v58, v12, s[64:67], 0 offen offset:512
    buffer_load_ushort v60, v12, s[64:67], 0 offen offset:1024
    v_mul_u32_u24 v13, 36, v11
    s_movk_i32 s91, 9216
    s_movk_i32 s92, 18432
    buffer_load_ushort v150, v12, s[68:71], 0 offen offset:0
    buffer_load_dword v148, v13, s[40:43], 0 offen offset:32
    buffer_load_ushort v154, v12, s[68:71], 0 offen offset:512
    buffer_load_dword v152, v13, s[40:43], s91 offen offset:32
    buffer_load_ushort v158, v12, s[68:71], 0 offen offset:1024
    buffer_load_dword v156, v13, s[40:43], s92 offen offset:32
    v_mul_u32_u24 v6, 43, v1
    v_lshrrev_b32 v6, 8, v6
    v_mul_u32_u24 v7, 6, v6
    v_sub_u32 v7, v1, v7
    s_and_b32 s90, s50, 1
    s_lshl_b32 s90, s90, 2
    v_lshlrev_b32 v7, 4, v7
    v_xor_b32 v6, s90, v6
    s_movk_i32 s90, 1152
    v_mad_u32_u24 v43, v6, s90, v7
    s_cmp_lg_u32 s50, 0
    s_cbranch_scc1 L_nozero_22
    v_add_u32 v6, 156672, v5
    v_mov_b64 v[160:161], 0
    v_mov_b64 v[162:163], 0
    ds_write_b128 v6, v[160:163]
    ds_write_b128 v6, v[160:163] offset:1024
L_nozero_22:
    v_mov_b32 v57, 0
    v_mov_b32 v149, 0
    v_mov_b32 v151, 0
    v_mov_b32 v59, 0
    v_mov_b32 v153, 0
    v_mov_b32 v155, 0
    v_mov_b32 v61, 0
    v_mov_b32 v157, 0
    v_mov_b32 v159, 0
    v_bfe_u32 v14, v11, 3, 1
    v_lshlrev_b32 v14, 2, v14
    v_xor_b32 v14, v14, v11
    v_mul_u32_u24 v14, 96, v14
    v_add_u32 v14, 73816, v14
    v_lshlrev_b32 v15, 4, v11
    v_add_u32 v15, 147456, v15
    v_mul_u32_u24 v6, 43, v1
    v_lshrrev_b32 v6, 8, v6
    v_mul_u32_u24 v7, 6, v6
    v_sub_u32 v7, v1, v7
    s_and_b32 s90, s84, 1
    s_lshl_b32 s90, s90, 2
    v_lshlrev_b32 v7, 4, v7
    v_xor_b32 v6, s90, v6
    s_movk_i32 s90, 1152
    v_lshrrev_b32 v8, 2, v6
    v_and_b32 v9, 3, v6
    v_lshl_add_u32 v8, v8, 3, v9
    v_mad_u32_u24 v244, v8, s90, v7
    v_lshrrev_b32 v8, 1, v6
    v_and_b32 v9, 1, v6
    v_mad_u32_u24 v8, v8, 18, v9
    v_mad_u32_u24 v245, v8, s90, v7
    v_mul_u32_u24 v249, 1152, v2
    v_lshl_add_u32 v248, v3, 4, v249
    v_and_b32 v6, 31, v1
    v_lshrrev_b32 v8, 5, v1
    v_lshlrev_b32 v7, 4, v6
    v_min_u32 v6, 19, v6
    v_mul_u32_u24 v8, 320, v8
    v_lshl_add_u32 v8, v6, 4, v8
    s_lshl_b32 s90, s48, 15
    s_lshl_b32 s91, s48, 12
    s_mul_i32 s92, s48, 40960
    s_add_u32 s91, s91, 65536
    s_add_u32 s92, s92, 73728
    v_add_u32 v33, s90, v5
    v_add_u32 v34, s91, v7
    v_add_u32 v35, s92, v8
    v_mov_b32 v32, 0xdddddddd
    s_mul_i32 s90, s87, 18432
    s_mul_i32 s91, s86, 72
    s_add_u32 s51, s90, s91
    v_and_b32 v6, 1, v1
    v_mov_b32 v7, 0x01000c0c
    v_cmp_eq_u32 vcc, 0, v6
    v_mov_b32 v8, 0x0c0c0100
    v_mov_b32 v9, 0x03020c0c
    v_cndmask_b32 v250, v7, v8, vcc
    v_mov_b32 v8, 0x0c0c0302
    v_cndmask_b32 v251, v9, v8, vcc
    v_lshlrev_b32 v6, 9, v3
    v_lshl_add_u32 v6, v2, 5, v6
    s_lshl2_add_u32 s90, s84, 157952
    v_add_u32 v252, s90, v6
    v_lshlrev_b32 v7, 2, v1
    v_add_u32 v7, 161536, v7
    v_lshrrev_b32 v6, 2, v1
    v_and_b32 v8, 1, v1
    v_lshl_add_u32 v6, v6, 1, v8
    v_bfe_u32 v8, v1, 1, 1
    v_lshlrev_b32 v8, 8, v8
    v_cmp_gt_u32 vcc, 48, v1
    v_lshl_add_u32 v6, v6, 2, v8
    v_add_u32 v6, 157184, v6
    v_cndmask_b32 v253, v7, v6, vcc
    v_lshlrev_b32 v6, 3, v3
    v_add_u32 v6, s84, v6
    v_lshlrev_b32 v7, 6, v6
    v_cmp_gt_u32 vcc, 18, v6
    v_lshl_add_u32 v7, v2, 2, v7
    v_mov_b32 v8, 268435456
    v_cndmask_b32 v254, v8, v7, vcc
    s_mul_i32 s90, s50, 3072
    s_lshl_b32 s91, s48, 15
    s_add_u32 s90, s90, s91
    v_add_u32 v246, s90, v5
    v_xor_b32 v247, 0x8000, v246
    s_lshl4_add_u32 s90, s87, s86
    s_lshl_b32 s22, s90, 10
    s_add_u32 s22, s22, 524288
    s_lshl_b32 s26, s87, 11
    s_add_u32 s26, s26, 2621440
    s_lshr_b32 s92, s86, 3
    s_lshl_b32 s92, s92, 10
    s_add_u32 s23, s26, s92
    s_and_b32 s93, s86, 1
    s_lshl_b32 s93, s93, 9
    s_add_u32 s23, s23, s93
    s_bfe_u32 s92, s86, 0x20001
    s_lshl_b32 s92, s92, 6
    s_add_u32 s23, s23, s92
    s_lshl_b32 s25, s87, 14
    s_add_u32 s25, s25, 524288
    s_lshl_b32 s27, s85, 11
    s_add_u32 s27, s27, 262144
    s_lshl_b32 s90, s86, 7
    s_add_u32 s24, s27, s90
    v_lshlrev_b32 v6, 8, v3
    v_cmp_gt_u32 vcc, 32, v1
    v_lshl_add_u32 v6, v2, 2, v6
    v_mov_b32 v7, 268435456
    v_cndmask_b32 v238, v7, v6, vcc
    s_cmp_lg_u32 s50, 0
    s_cbranch_scc1 L_nocp_23
    s_getpc_b64 s[92:93]
L_pc_24:
    s_sub_u32 s92, s92, L_pc_24-gated_mix__grouped_kv_mqa__moe_arch_mod__prompt_kernel
    s_subb_u32 s93, s93, 0
    s_lshr_b32 s90, s2, 3
    s_mul_i32 s90, s90, 12
    v_add_u32 v6, s90, v1
    v_lshlrev_b32 v6, 7, v6
    v_min_u32 v6, L_code_end-gated_mix__grouped_kv_mqa__moe_arch_mod__prompt_kernel-4, v6
    v_cmp_gt_u32 vcc, 12, v1
    s_nop 0
    s_and_saveexec_b64 s[96:97], vcc
    s_cbranch_execz L_skip_25
    global_load_dword v62, v6, s[92:93]
L_skip_25:
    s_mov_b64 exec, s[96:97]
L_nocp_23:
    s_waitcnt vmcnt(0)
    ds_write_b64 v14, v[56:57] offset:0
    ds_write_b128 v15, v[148:151] offset:0
    ds_write_b64 v14, v[58:59] offset:24576
    ds_write_b128 v15, v[152:155] offset:4096
    s_cmp_lg_u32 s50, 0
    s_cbranch_scc1 L_vec2_26
    ds_write_b64 v14, v[60:61] offset:49152
    ds_write_b128 v15, v[156:159] offset:8192
L_vec2_26:
    s_waitcnt lgkmcnt(0)
    s_barrier
    v_lshrrev_b32 v6, 3, v1
    s_mul_i32 s90, s87, 18432
    v_and_b32 v7, 6, v6
    v_and_b32 v8, 7, v1
    s_mul_i32 s91, s50, 18432
    v_xor_b32 v7, v7, v8
    v_mul_u32_u24 v6, 1152, v6
    v_lshl_add_u32 v9, v7, 4, v6
    v_add_u32 v10, 9216, v9
    s_mov_b32 m0, s91
    s_nop 0
    buffer_load_dwordx4 v9, s[32:35], s90 offen lds
    s_add_u32 m0, m0, 1024
    s_mov_b32 s82, 268435456
    buffer_load_dwordx4 v10, s[32:35], s90 offen lds
    s_add_u32 m0, m0, 896
    s_mov_b32 s83, 0x20000
    buffer_load_dwordx4 v9, s[32:35], s90 offen offset:128 lds
    s_add_u32 m0, m0, 1024
    s_mov_b32 s78, 256
    buffer_load_dwordx4 v10, s[32:35], s90 offen offset:128 lds
    s_add_u32 m0, m0, 896
    s_mov_b32 s79, 0x20000
    buffer_load_dwordx4 v9, s[32:35], s90 offen offset:256 lds
    s_add_u32 m0, m0, 1024
    s_load_dwordx2 s[44:45], s[0:1], 32
    buffer_load_dwordx4 v10, s[32:35], s90 offen offset:256 lds
    s_add_u32 m0, m0, 896
    s_load_dwordx2 s[72:73], s[0:1], 88
    buffer_load_dwordx4 v9, s[32:35], s90 offen offset:384 lds
    s_add_u32 m0, m0, 1024
    s_load_dwordx2 s[52:53], s[0:1], 56
    buffer_load_dwordx4 v10, s[32:35], s90 offen offset:384 lds
    s_add_u32 m0, m0, 896
    s_load_dwordx2 s[56:57], s[0:1], 64
    buffer_load_dwordx4 v9, s[32:35], s90 offen offset:512 lds
    s_add_u32 m0, m0, 1024
    s_load_dwordx2 s[60:61], s[0:1], 72
    buffer_load_dwordx4 v10, s[32:35], s90 offen offset:512 lds
    s_add_u32 m0, m0, 896
    s_mov_b32 s46, 663552
    buffer_load_dwordx4 v9, s[32:35], s90 offen offset:640 lds
    s_add_u32 m0, m0, 1024
    s_mov_b32 s47, 0x20000
    buffer_load_dwordx4 v10, s[32:35], s90 offen offset:640 lds
    s_add_u32 m0, m0, 896
    s_mov_b32 s74, 2359296
    buffer_load_dwordx4 v9, s[32:35], s90 offen offset:768 lds
    s_add_u32 m0, m0, 1024
    s_mov_b32 s75, 0x20000
    buffer_load_dwordx4 v10, s[32:35], s90 offen offset:768 lds
    s_add_u32 m0, m0, 896
    s_mov_b32 s54, 5308416
    buffer_load_dwordx4 v9, s[32:35], s90 offen offset:896 lds
    s_add_u32 m0, m0, 1024
    s_mov_b32 s55, 0x20000
    buffer_load_dwordx4 v10, s[32:35], s90 offen offset:896 lds
    s_add_u32 m0, m0, 896
    s_mov_b32 s58, 5308416
    buffer_load_dwordx4 v9, s[32:35], s90 offen offset:1024 lds
    s_add_u32 m0, m0, 1024
    s_mov_b32 s59, 0x20000
    buffer_load_dwordx4 v10, s[32:35], s90 offen offset:1024 lds
    s_mov_b32 s62, 5308416
    s_mov_b32 s63, 0x20000
    v_and_b32 v14, 7, v2
    v_and_b32 v15, 6, v14
    v_xor_b32 v12, v15, v3
    v_lshrrev_b32 v15, 3, v2
    v_lshlrev_b32 v15, 10, v15
    v_lshl_add_u32 v15, v14, 7, v15
    s_mul_i32 s95, s50, 18432
    v_add_u32 v15, s95, v15
    v_xor_b32 v13, 4, v12
    v_lshl_add_u32 v12, v12, 4, v15
    v_lshl_add_u32 v13, v13, 4, v15
    v_bfe_u32 v6, v1, 2, 2
    v_and_b32 v7, 3, v1
    v_and_b32 v8, 1, v3
    v_lshl_add_u32 v9, v3, 3, v6
    v_lshl_add_u32 v8, v8, 2, v9
    v_lshlrev_b32 v10, 3, v7
    v_xor_b32 v11, 4, v8
    v_mul_u32_u24 v8, 96, v8
    v_mul_u32_u24 v11, 96, v11
    v_add_u32 v8, 73728, v8
    v_add_u32 v11, 73728, v11
    v_add_u32 v240, v8, v10
    v_add_u32 v241, v11, v10
    v_and_b32 v7, 1, v7
    v_mul_u32_u24 v7, 24, v7
    v_add_u32 v7, 64, v7
    v_add_u32 v242, v8, v7
    v_add_u32 v243, v11, v7
    s_barrier
    s_mul_i32 s95, s86, 72
    s_mul_i32 s90, s50, 9216
    s_mul_i32 s91, s50, 768
    s_add_u32 s90, s90, s95
    s_add_u32 s91, s91, 73728
    s_xor_b32 s92, s86, s85
    s_and_b32 s92, s92, 1
    s_mul_i32 s93, s92, 626688
    s_add_u32 s90, s90, s93
    s_mul_i32 s93, s92, 52224
    s_add_u32 m0, s91, s93
    s_mul_i32 s93, s92, -73728
    s_add_u32 s93, s93, 36864
    s_mul_i32 s92, s92, -6144
    s_add_u32 s92, s92, 3072
    s_mov_b32 exec_lo, 0xdf7df7df
    s_mov_b32 exec_hi, 0x7df7
    buffer_load_dwordx4 v43, s[36:39], s90 offen lds
    s_add_u32 m0, m0, s92
    s_add_u32 s90, s90, s93
    buffer_load_dwordx4 v43, s[36:39], s90 offen lds
    s_add_u32 m0, m0, s92
    s_add_u32 s90, s90, s93
    buffer_load_dwordx4 v43, s[36:39], s90 offen lds
    s_add_u32 m0, m0, s92
    s_add_u32 s90, s90, s93
    buffer_load_dwordx4 v43, s[36:39], s90 offen lds
    s_add_u32 m0, m0, s92
    s_add_u32 s90, s90, s93
    buffer_load_dwordx4 v43, s[36:39], s90 offen lds
    s_add_u32 m0, m0, s92
    s_add_u32 s90, s90, s93
    buffer_load_dwordx4 v43, s[36:39], s90 offen lds
    s_add_u32 m0, m0, s92
    s_add_u32 s90, s90, s93
    buffer_load_dwordx4 v43, s[36:39], s90 offen lds
    s_add_u32 m0, m0, s92
    s_add_u32 s90, s90, s93
    buffer_load_dwordx4 v43, s[36:39], s90 offen lds
    s_add_u32 m0, m0, s92
    s_add_u32 s90, s90, s93
    buffer_load_dwordx4 v43, s[36:39], s90 offen lds
    s_add_u32 m0, m0, s92
    s_add_u32 s90, s90, s93
    buffer_load_dwordx4 v43, s[36:39], s90 offen lds
    s_add_u32 m0, m0, s92
    s_add_u32 s90, s90, s93
    buffer_load_dwordx4 v43, s[36:39], s90 offen lds
    s_add_u32 m0, m0, s92
    s_add_u32 s90, s90, s93
    buffer_load_dwordx4 v43, s[36:39], s90 offen lds
    s_add_u32 m0, m0, s92
    s_add_u32 s90, s90, s93
    buffer_load_dwordx4 v43, s[36:39], s90 offen lds
    s_add_u32 m0, m0, s92
    s_add_u32 s90, s90, s93
    buffer_load_dwordx4 v43, s[36:39], s90 offen lds
    s_add_u32 m0, m0, s92
    s_add_u32 s90, s90, s93
    buffer_load_dwordx4 v43, s[36:39], s90 offen lds
    s_add_u32 m0, m0, s92
    s_add_u32 s90, s90, s93
    buffer_load_dwordx4 v43, s[36:39], s90 offen lds
    s_add_u32 m0, m0, s92
    s_add_u32 s90, s90, s93
    buffer_load_dwordx4 v43, s[36:39], s90 offen lds
    s_add_u32 m0, m0, s92
    s_add_u32 s90, s90, s93
    buffer_load_dwordx4 v43, s[36:39], s90 offen lds
    s_mov_b64 exec, -1
    s_waitcnt vmcnt(18) lgkmcnt(0)
    ds_read_b128 v[64:67], v12 offset:0
    ds_read_b128 v[68:71], v13 offset:0
    ds_read_b128 v[72:75], v12 offset:2048
    ds_read_b128 v[76:79], v13 offset:2048
    ds_read_b128 v[80:83], v12 offset:4096
    ds_read_b128 v[84:87], v13 offset:4096
    ds_read_b128 v[88:91], v12 offset:6144
    ds_read_b128 v[92:95], v13 offset:6144
    ds_read_b128 v[96:99], v12 offset:8192
    ds_read_b128 v[100:103], v13 offset:8192
    ds_read_b128 v[104:107], v12 offset:10240
    ds_read_b128 v[108:111], v13 offset:10240
    ds_read_b128 v[112:115], v12 offset:12288
    ds_read_b128 v[116:119], v13 offset:12288
    s_waitcnt lgkmcnt(8)
    ds_read_b128 v[120:123], v12 offset:14336
    ds_read_b128 v[124:127], v13 offset:14336
    ds_read_b128 v[128:131], v12 offset:16384
    ds_read_b128 v[132:135], v13 offset:16384
    s_waitcnt vmcnt(0) lgkmcnt(0)
    s_barrier
    s_branch L_qproj_2
L_nokv_5:
    v_lshl_add_u32 v11, s50, 6, v1
    v_lshlrev_b32 v12, 1, v11
    buffer_load_ushort v56, v12, s[64:67], 0 offen offset:0
    buffer_load_ushort v58, v12, s[64:67], 0 offen offset:512
    buffer_load_ushort v60, v12, s[64:67], 0 offen offset:1024
    v_mul_u32_u24 v6, 43, v1
    v_lshrrev_b32 v6, 8, v6
    v_mul_u32_u24 v7, 6, v6
    v_sub_u32 v7, v1, v7
    s_and_b32 s90, s50, 1
    s_lshl_b32 s90, s90, 2
    v_lshlrev_b32 v7, 4, v7
    v_xor_b32 v6, s90, v6
    s_movk_i32 s90, 1152
    v_mad_u32_u24 v43, v6, s90, v7
    s_cmp_lg_u32 s50, 0
    s_cbranch_scc1 L_nozero_29
    v_add_u32 v6, 156672, v5
    v_mov_b64 v[160:161], 0
    v_mov_b64 v[162:163], 0
    ds_write_b128 v6, v[160:163]
    ds_write_b128 v6, v[160:163] offset:1024
L_nozero_29:
    v_mov_b32 v57, 0
    v_mov_b32 v59, 0
    v_mov_b32 v61, 0
    v_bfe_u32 v14, v11, 3, 1
    v_lshlrev_b32 v14, 2, v14
    v_xor_b32 v14, v14, v11
    v_mul_u32_u24 v14, 96, v14
    v_add_u32 v14, 73816, v14
    s_mul_i32 s95, s86, 72
    s_mul_i32 s90, s50, 9216
    s_mul_i32 s91, s50, 768
    s_add_u32 s90, s90, s95
    s_add_u32 s91, s91, 73728
    s_xor_b32 s92, s86, s85
    s_and_b32 s92, s92, 1
    s_mul_i32 s93, s92, 626688
    s_add_u32 s90, s90, s93
    s_mul_i32 s93, s92, 52224
    s_add_u32 m0, s91, s93
    s_mul_i32 s93, s92, -73728
    s_add_u32 s93, s93, 36864
    s_mul_i32 s92, s92, -6144
    s_add_u32 s92, s92, 3072
    s_mov_b32 exec_lo, 0xdf7df7df
    s_mov_b32 exec_hi, 0x7df7
    buffer_load_dwordx4 v43, s[36:39], s90 offen lds
    s_add_u32 m0, m0, s92
    s_add_u32 s90, s90, s93
    buffer_load_dwordx4 v43, s[36:39], s90 offen lds
    s_add_u32 m0, m0, s92
    s_add_u32 s90, s90, s93
    buffer_load_dwordx4 v43, s[36:39], s90 offen lds
    s_add_u32 m0, m0, s92
    s_add_u32 s90, s90, s93
    buffer_load_dwordx4 v43, s[36:39], s90 offen lds
    s_add_u32 m0, m0, s92
    s_add_u32 s90, s90, s93
    buffer_load_dwordx4 v43, s[36:39], s90 offen lds
    s_add_u32 m0, m0, s92
    s_add_u32 s90, s90, s93
    buffer_load_dwordx4 v43, s[36:39], s90 offen lds
    s_add_u32 m0, m0, s92
    s_add_u32 s90, s90, s93
    buffer_load_dwordx4 v43, s[36:39], s90 offen lds
    s_add_u32 m0, m0, s92
    s_add_u32 s90, s90, s93
    buffer_load_dwordx4 v43, s[36:39], s90 offen lds
    s_add_u32 m0, m0, s92
    s_add_u32 s90, s90, s93
    buffer_load_dwordx4 v43, s[36:39], s90 offen lds
    s_add_u32 m0, m0, s92
    s_add_u32 s90, s90, s93
    buffer_load_dwordx4 v43, s[36:39], s90 offen lds
    s_add_u32 m0, m0, s92
    s_add_u32 s90, s90, s93
    buffer_load_dwordx4 v43, s[36:39], s90 offen lds
    s_add_u32 m0, m0, s92
    s_add_u32 s90, s90, s93
    buffer_load_dwordx4 v43, s[36:39], s90 offen lds
    s_add_u32 m0, m0, s92
    s_add_u32 s90, s90, s93
    buffer_load_dwordx4 v43, s[36:39], s90 offen lds
    s_add_u32 m0, m0, s92
    s_add_u32 s90, s90, s93
    buffer_load_dwordx4 v43, s[36:39], s90 offen lds
    s_add_u32 m0, m0, s92
    s_add_u32 s90, s90, s93
    buffer_load_dwordx4 v43, s[36:39], s90 offen lds
    s_add_u32 m0, m0, s92
    s_add_u32 s90, s90, s93
    buffer_load_dwordx4 v43, s[36:39], s90 offen lds
    s_add_u32 m0, m0, s92
    s_add_u32 s90, s90, s93
    buffer_load_dwordx4 v43, s[36:39], s90 offen lds
    s_add_u32 m0, m0, s92
    s_add_u32 s90, s90, s93
    buffer_load_dwordx4 v43, s[36:39], s90 offen lds
    s_mov_b64 exec, -1
    v_mul_u32_u24 v6, 43, v1
    v_lshrrev_b32 v6, 8, v6
    v_mul_u32_u24 v7, 6, v6
    v_sub_u32 v7, v1, v7
    s_and_b32 s90, s84, 1
    s_lshl_b32 s90, s90, 2
    v_lshlrev_b32 v7, 4, v7
    v_xor_b32 v6, s90, v6
    s_movk_i32 s90, 1152
    v_lshrrev_b32 v8, 2, v6
    v_and_b32 v9, 3, v6
    v_lshl_add_u32 v8, v8, 3, v9
    v_mad_u32_u24 v244, v8, s90, v7
    v_lshrrev_b32 v8, 1, v6
    v_and_b32 v9, 1, v6
    v_mad_u32_u24 v8, v8, 18, v9
    v_mad_u32_u24 v245, v8, s90, v7
    v_mul_u32_u24 v249, 1152, v2
    v_lshl_add_u32 v248, v3, 4, v249
    v_and_b32 v6, 31, v1
    v_lshrrev_b32 v8, 5, v1
    v_lshlrev_b32 v7, 4, v6
    v_min_u32 v6, 19, v6
    v_mul_u32_u24 v8, 320, v8
    v_lshl_add_u32 v8, v6, 4, v8
    s_lshl_b32 s90, s48, 15
    s_lshl_b32 s91, s48, 12
    s_mul_i32 s92, s48, 40960
    s_add_u32 s91, s91, 65536
    s_add_u32 s92, s92, 73728
    v_add_u32 v33, s90, v5
    v_add_u32 v34, s91, v7
    v_add_u32 v35, s92, v8
    v_mov_b32 v32, 0xdddddddd
    s_mul_i32 s90, s87, 18432
    s_mul_i32 s91, s86, 72
    s_add_u32 s51, s90, s91
    v_and_b32 v6, 1, v1
    v_mov_b32 v7, 0x01000c0c
    v_cmp_eq_u32 vcc, 0, v6
    v_mov_b32 v8, 0x0c0c0100
    v_mov_b32 v9, 0x03020c0c
    v_cndmask_b32 v250, v7, v8, vcc
    v_mov_b32 v8, 0x0c0c0302
    v_cndmask_b32 v251, v9, v8, vcc
    v_lshlrev_b32 v6, 9, v3
    v_lshl_add_u32 v6, v2, 5, v6
    s_lshl2_add_u32 s90, s84, 157952
    v_add_u32 v252, s90, v6
    v_lshlrev_b32 v7, 2, v1
    v_add_u32 v7, 161536, v7
    v_lshrrev_b32 v6, 2, v1
    v_and_b32 v8, 1, v1
    v_lshl_add_u32 v6, v6, 1, v8
    v_bfe_u32 v8, v1, 1, 1
    v_lshlrev_b32 v8, 8, v8
    v_cmp_gt_u32 vcc, 48, v1
    v_lshl_add_u32 v6, v6, 2, v8
    v_add_u32 v6, 157184, v6
    v_cndmask_b32 v253, v7, v6, vcc
    v_lshlrev_b32 v6, 3, v3
    v_add_u32 v6, s84, v6
    v_lshlrev_b32 v7, 6, v6
    v_cmp_gt_u32 vcc, 18, v6
    v_lshl_add_u32 v7, v2, 2, v7
    v_mov_b32 v8, 268435456
    v_cndmask_b32 v254, v8, v7, vcc
    s_mul_i32 s90, s50, 3072
    s_lshl_b32 s91, s48, 15
    s_add_u32 s90, s90, s91
    v_add_u32 v246, s90, v5
    v_xor_b32 v247, 0x8000, v246
    s_lshl4_add_u32 s90, s87, s86
    s_lshl_b32 s22, s90, 10
    s_add_u32 s22, s22, 524288
    s_lshl_b32 s26, s87, 11
    s_add_u32 s26, s26, 2621440
    s_lshr_b32 s92, s86, 3
    s_lshl_b32 s92, s92, 10
    s_add_u32 s23, s26, s92
    s_and_b32 s93, s86, 1
    s_lshl_b32 s93, s93, 9
    s_add_u32 s23, s23, s93
    s_bfe_u32 s92, s86, 0x20001
    s_lshl_b32 s92, s92, 6
    s_add_u32 s23, s23, s92
    s_lshl_b32 s25, s87, 14
    s_add_u32 s25, s25, 524288
    s_lshl_b32 s27, s85, 11
    s_add_u32 s27, s27, 262144
    s_lshl_b32 s90, s86, 7
    s_add_u32 s24, s27, s90
    v_lshlrev_b32 v6, 8, v3
    v_cmp_gt_u32 vcc, 32, v1
    v_lshl_add_u32 v6, v2, 2, v6
    v_mov_b32 v7, 268435456
    v_cndmask_b32 v238, v7, v6, vcc
    s_cmp_lg_u32 s50, 0
    s_cbranch_scc1 L_nocp_30
    s_getpc_b64 s[92:93]
L_pc_31:
    s_sub_u32 s92, s92, L_pc_31-gated_mix__grouped_kv_mqa__moe_arch_mod__prompt_kernel
    s_subb_u32 s93, s93, 0
    s_lshr_b32 s90, s2, 3
    s_mul_i32 s90, s90, 12
    v_add_u32 v6, s90, v1
    v_lshlrev_b32 v6, 7, v6
    v_min_u32 v6, L_code_end-gated_mix__grouped_kv_mqa__moe_arch_mod__prompt_kernel-4, v6
    v_cmp_gt_u32 vcc, 12, v1
    s_nop 0
    s_and_saveexec_b64 s[96:97], vcc
    s_cbranch_execz L_skip_32
    global_load_dword v62, v6, s[92:93]
L_skip_32:
    s_mov_b64 exec, s[96:97]
L_nocp_30:
    s_waitcnt vmcnt(18)
    ds_write_b64 v14, v[56:57] offset:0
    ds_write_b64 v14, v[58:59] offset:24576
    s_cmp_lg_u32 s50, 0
    s_cbranch_scc1 L_vec2_33
    ds_write_b64 v14, v[60:61] offset:49152
L_vec2_33:
    s_waitcnt vmcnt(0) lgkmcnt(0)
    s_barrier
    s_setprio 3
    v_lshrrev_b32 v6, 3, v1
    s_mul_i32 s90, s87, 18432
    v_and_b32 v7, 6, v6
    v_and_b32 v8, 7, v1
    s_mul_i32 s91, s50, 18432
    v_xor_b32 v7, v7, v8
    v_mul_u32_u24 v6, 1152, v6
    v_lshl_add_u32 v9, v7, 4, v6
    v_add_u32 v10, 9216, v9
    s_mov_b32 m0, s91
    s_nop 0
    buffer_load_dwordx4 v9, s[32:35], s90 offen lds
    s_add_u32 m0, m0, 1024
    s_nop 0
    buffer_load_dwordx4 v10, s[32:35], s90 offen lds
    s_add_u32 m0, m0, 896
    s_nop 0
    buffer_load_dwordx4 v9, s[32:35], s90 offen offset:128 lds
    s_add_u32 m0, m0, 1024
    s_nop 0
    buffer_load_dwordx4 v10, s[32:35], s90 offen offset:128 lds
    s_add_u32 m0, m0, 896
    s_nop 0
    buffer_load_dwordx4 v9, s[32:35], s90 offen offset:256 lds
    s_add_u32 m0, m0, 1024
    s_nop 0
    buffer_load_dwordx4 v10, s[32:35], s90 offen offset:256 lds
    s_add_u32 m0, m0, 896
    s_nop 0
    buffer_load_dwordx4 v9, s[32:35], s90 offen offset:384 lds
    s_add_u32 m0, m0, 1024
    s_nop 0
    buffer_load_dwordx4 v10, s[32:35], s90 offen offset:384 lds
    s_add_u32 m0, m0, 896
    s_nop 0
    buffer_load_dwordx4 v9, s[32:35], s90 offen offset:512 lds
    s_add_u32 m0, m0, 1024
    s_nop 0
    buffer_load_dwordx4 v10, s[32:35], s90 offen offset:512 lds
    s_add_u32 m0, m0, 896
    s_nop 0
    buffer_load_dwordx4 v9, s[32:35], s90 offen offset:640 lds
    s_add_u32 m0, m0, 1024
    s_nop 0
    buffer_load_dwordx4 v10, s[32:35], s90 offen offset:640 lds
    s_add_u32 m0, m0, 896
    s_nop 0
    buffer_load_dwordx4 v9, s[32:35], s90 offen offset:768 lds
    s_add_u32 m0, m0, 1024
    s_nop 0
    buffer_load_dwordx4 v10, s[32:35], s90 offen offset:768 lds
    s_add_u32 m0, m0, 896
    s_nop 0
    buffer_load_dwordx4 v9, s[32:35], s90 offen offset:896 lds
    s_add_u32 m0, m0, 1024
    s_nop 0
    buffer_load_dwordx4 v10, s[32:35], s90 offen offset:896 lds
    s_add_u32 m0, m0, 896
    s_nop 0
    buffer_load_dwordx4 v9, s[32:35], s90 offen offset:1024 lds
    s_add_u32 m0, m0, 1024
    s_nop 0
    buffer_load_dwordx4 v10, s[32:35], s90 offen offset:1024 lds
    s_setprio 0
    s_mov_b32 s82, 268435456
    s_mov_b32 s83, 0x20000
    s_mov_b32 s78, 256
    s_mov_b32 s79, 0x20000
    s_load_dwordx2 s[44:45], s[0:1], 32
    s_load_dwordx2 s[72:73], s[0:1], 88
    s_load_dwordx2 s[52:53], s[0:1], 56
    s_load_dwordx2 s[56:57], s[0:1], 64
    s_load_dwordx2 s[60:61], s[0:1], 72
    s_mov_b32 s46, 663552
    s_mov_b32 s47, 0x20000
    s_mov_b32 s74, 2359296
    s_mov_b32 s75, 0x20000
    s_mov_b32 s54, 5308416
    s_mov_b32 s55, 0x20000
    s_mov_b32 s58, 5308416
    s_mov_b32 s59, 0x20000
    s_mov_b32 s62, 5308416
    s_mov_b32 s63, 0x20000
    v_and_b32 v14, 7, v2
    v_and_b32 v15, 6, v14
    v_xor_b32 v12, v15, v3
    v_lshrrev_b32 v15, 3, v2
    v_lshlrev_b32 v15, 10, v15
    v_lshl_add_u32 v15, v14, 7, v15
    s_mul_i32 s95, s50, 18432
    v_add_u32 v15, s95, v15
    v_xor_b32 v13, 4, v12
    v_lshl_add_u32 v12, v12, 4, v15
    v_lshl_add_u32 v13, v13, 4, v15
    v_bfe_u32 v6, v1, 2, 2
    v_and_b32 v7, 3, v1
    v_and_b32 v8, 1, v3
    v_lshl_add_u32 v9, v3, 3, v6
    v_lshl_add_u32 v8, v8, 2, v9
    v_lshlrev_b32 v10, 3, v7
    v_xor_b32 v11, 4, v8
    v_mul_u32_u24 v8, 96, v8
    v_mul_u32_u24 v11, 96, v11
    v_add_u32 v8, 73728, v8
    v_add_u32 v11, 73728, v11
    v_add_u32 v240, v8, v10
    v_add_u32 v241, v11, v10
    v_and_b32 v7, 1, v7
    v_mul_u32_u24 v7, 24, v7
    v_add_u32 v7, 64, v7
    v_add_u32 v242, v8, v7
    v_add_u32 v243, v11, v7
    s_waitcnt vmcnt(0) lgkmcnt(0)
    ds_read_b128 v[64:67], v12 offset:0
    ds_read_b128 v[68:71], v13 offset:0
    ds_read_b128 v[72:75], v12 offset:2048
    ds_read_b128 v[76:79], v13 offset:2048
    ds_read_b128 v[80:83], v12 offset:4096
    ds_read_b128 v[84:87], v13 offset:4096
    ds_read_b128 v[88:91], v12 offset:6144
    ds_read_b128 v[92:95], v13 offset:6144
    ds_read_b128 v[96:99], v12 offset:8192
    ds_read_b128 v[100:103], v13 offset:8192
    ds_read_b128 v[104:107], v12 offset:10240
    ds_read_b128 v[108:111], v13 offset:10240
    ds_read_b128 v[112:115], v12 offset:12288
    ds_read_b128 v[116:119], v13 offset:12288
    s_waitcnt lgkmcnt(8)
    ds_read_b128 v[120:123], v12 offset:14336
    ds_read_b128 v[124:127], v13 offset:14336
    ds_read_b128 v[128:131], v12 offset:16384
    ds_read_b128 v[132:135], v13 offset:16384
    s_waitcnt lgkmcnt(0)
L_qproj_2:
    ds_read_b64_tr_b16 v[188:189], v240 offset:0
    ds_read_b64_tr_b16 v[190:191], v241 offset:0
    ds_read_b64_tr_b16 v[192:193], v240 offset:32
    ds_read_b64_tr_b16 v[194:195], v241 offset:32
    ds_read_b64_tr_b16 v[196:197], v242 offset:0
    ds_read_b64_tr_b16 v[198:199], v243 offset:0
    ds_read_b64_tr_b16 v[200:201], v240 offset:3072
    ds_read_b64_tr_b16 v[202:203], v241 offset:3072
    ds_read_b64_tr_b16 v[204:205], v240 offset:3104
    ds_read_b64_tr_b16 v[206:207], v241 offset:3104
    ds_read_b64_tr_b16 v[208:209], v242 offset:3072
    ds_read_b64_tr_b16 v[210:211], v243 offset:3072
    s_waitcnt lgkmcnt(6)
    v_mfma_f32_16x16x32_bf16 v[224:227], v[188:191], v[64:67], 0
    ds_read_b64_tr_b16 v[212:213], v240 offset:6144
    ds_read_b64_tr_b16 v[214:215], v241 offset:6144
    v_mfma_f32_16x16x32_bf16 v[228:231], v[192:195], v[64:67], 0
    ds_read_b64_tr_b16 v[216:217], v240 offset:6176
    ds_read_b64_tr_b16 v[218:219], v241 offset:6176
    v_mfma_f32_16x16x32_bf16 v[232:235], v[196:199], v[64:67], 0
    ds_read_b64_tr_b16 v[220:221], v242 offset:6144
    ds_read_b64_tr_b16 v[222:223], v243 offset:6144
    s_waitcnt lgkmcnt(6)
    v_mfma_f32_16x16x32_bf16 v[224:227], v[200:203], v[68:71], v[224:227]
    ds_read_b64_tr_b16 v[188:189], v240 offset:9216
    ds_read_b64_tr_b16 v[190:191], v241 offset:9216
    v_mfma_f32_16x16x32_bf16 v[228:231], v[204:207], v[68:71], v[228:231]
    ds_read_b64_tr_b16 v[192:193], v240 offset:9248
    ds_read_b64_tr_b16 v[194:195], v241 offset:9248
    v_mfma_f32_16x16x32_bf16 v[232:235], v[208:211], v[68:71], v[232:235]
    ds_read_b64_tr_b16 v[196:197], v242 offset:9216
    ds_read_b64_tr_b16 v[198:199], v243 offset:9216
    s_waitcnt lgkmcnt(6)
    v_mfma_f32_16x16x32_bf16 v[224:227], v[212:215], v[72:75], v[224:227]
    ds_read_b64_tr_b16 v[200:201], v240 offset:12288
    ds_read_b64_tr_b16 v[202:203], v241 offset:12288
    v_mfma_f32_16x16x32_bf16 v[228:231], v[216:219], v[72:75], v[228:231]
    ds_read_b64_tr_b16 v[204:205], v240 offset:12320
    ds_read_b64_tr_b16 v[206:207], v241 offset:12320
    v_mfma_f32_16x16x32_bf16 v[232:235], v[220:223], v[72:75], v[232:235]
    ds_read_b64_tr_b16 v[208:209], v242 offset:12288
    ds_read_b64_tr_b16 v[210:211], v243 offset:12288
    s_waitcnt lgkmcnt(6)
    v_mfma_f32_16x16x32_bf16 v[224:227], v[188:191], v[76:79], v[224:227]
    ds_read_b64_tr_b16 v[212:213], v240 offset:15360
    ds_read_b64_tr_b16 v[214:215], v241 offset:15360
    v_mfma_f32_16x16x32_bf16 v[228:231], v[192:195], v[76:79], v[228:231]
    ds_read_b64_tr_b16 v[216:217], v240 offset:15392
    ds_read_b64_tr_b16 v[218:219], v241 offset:15392
    v_mfma_f32_16x16x32_bf16 v[232:235], v[196:199], v[76:79], v[232:235]
    ds_read_b64_tr_b16 v[220:221], v242 offset:15360
    ds_read_b64_tr_b16 v[222:223], v243 offset:15360
    s_waitcnt lgkmcnt(6)
    v_mfma_f32_16x16x32_bf16 v[224:227], v[200:203], v[80:83], v[224:227]
    ds_read_b64_tr_b16 v[188:189], v240 offset:18432
    ds_read_b64_tr_b16 v[190:191], v241 offset:18432
    v_mfma_f32_16x16x32_bf16 v[228:231], v[204:207], v[80:83], v[228:231]
    ds_read_b64_tr_b16 v[192:193], v240 offset:18464
    ds_read_b64_tr_b16 v[194:195], v241 offset:18464
    v_mfma_f32_16x16x32_bf16 v[232:235], v[208:211], v[80:83], v[232:235]
    ds_read_b64_tr_b16 v[196:197], v242 offset:18432
    ds_read_b64_tr_b16 v[198:199], v243 offset:18432
    s_waitcnt lgkmcnt(6)
    v_mfma_f32_16x16x32_bf16 v[224:227], v[212:215], v[84:87], v[224:227]
    ds_read_b64_tr_b16 v[200:201], v240 offset:21504
    ds_read_b64_tr_b16 v[202:203], v241 offset:21504
    v_mfma_f32_16x16x32_bf16 v[228:231], v[216:219], v[84:87], v[228:231]
    ds_read_b64_tr_b16 v[204:205], v240 offset:21536
    ds_read_b64_tr_b16 v[206:207], v241 offset:21536
    v_mfma_f32_16x16x32_bf16 v[232:235], v[220:223], v[84:87], v[232:235]
    ds_read_b64_tr_b16 v[208:209], v242 offset:21504
    ds_read_b64_tr_b16 v[210:211], v243 offset:21504
    s_waitcnt lgkmcnt(6)
    v_mfma_f32_16x16x32_bf16 v[224:227], v[188:191], v[88:91], v[224:227]
    ds_read_b64_tr_b16 v[212:213], v240 offset:24576
    ds_read_b64_tr_b16 v[214:215], v241 offset:24576
    v_mfma_f32_16x16x32_bf16 v[228:231], v[192:195], v[88:91], v[228:231]
    ds_read_b64_tr_b16 v[216:217], v240 offset:24608
    ds_read_b64_tr_b16 v[218:219], v241 offset:24608
    v_mfma_f32_16x16x32_bf16 v[232:235], v[196:199], v[88:91], v[232:235]
    ds_read_b64_tr_b16 v[220:221], v242 offset:24576
    ds_read_b64_tr_b16 v[222:223], v243 offset:24576
    s_waitcnt lgkmcnt(6)
    v_mfma_f32_16x16x32_bf16 v[224:227], v[200:203], v[92:95], v[224:227]
    ds_read_b64_tr_b16 v[188:189], v240 offset:27648
    ds_read_b64_tr_b16 v[190:191], v241 offset:27648
    v_mfma_f32_16x16x32_bf16 v[228:231], v[204:207], v[92:95], v[228:231]
    ds_read_b64_tr_b16 v[192:193], v240 offset:27680
    ds_read_b64_tr_b16 v[194:195], v241 offset:27680
    v_mfma_f32_16x16x32_bf16 v[232:235], v[208:211], v[92:95], v[232:235]
    ds_read_b64_tr_b16 v[196:197], v242 offset:27648
    ds_read_b64_tr_b16 v[198:199], v243 offset:27648
    s_waitcnt lgkmcnt(6)
    v_mfma_f32_16x16x32_bf16 v[224:227], v[212:215], v[96:99], v[224:227]
    ds_read_b64_tr_b16 v[200:201], v240 offset:30720
    ds_read_b64_tr_b16 v[202:203], v241 offset:30720
    v_mfma_f32_16x16x32_bf16 v[228:231], v[216:219], v[96:99], v[228:231]
    ds_read_b64_tr_b16 v[204:205], v240 offset:30752
    ds_read_b64_tr_b16 v[206:207], v241 offset:30752
    v_mfma_f32_16x16x32_bf16 v[232:235], v[220:223], v[96:99], v[232:235]
    ds_read_b64_tr_b16 v[208:209], v242 offset:30720
    ds_read_b64_tr_b16 v[210:211], v243 offset:30720
    s_waitcnt lgkmcnt(6)
    v_mfma_f32_16x16x32_bf16 v[224:227], v[188:191], v[100:103], v[224:227]
    ds_read_b64_tr_b16 v[212:213], v240 offset:33792
    ds_read_b64_tr_b16 v[214:215], v241 offset:33792
    v_mfma_f32_16x16x32_bf16 v[228:231], v[192:195], v[100:103], v[228:231]
    ds_read_b64_tr_b16 v[216:217], v240 offset:33824
    ds_read_b64_tr_b16 v[218:219], v241 offset:33824
    v_mfma_f32_16x16x32_bf16 v[232:235], v[196:199], v[100:103], v[232:235]
    ds_read_b64_tr_b16 v[220:221], v242 offset:33792
    ds_read_b64_tr_b16 v[222:223], v243 offset:33792
    s_waitcnt lgkmcnt(6)
    v_mfma_f32_16x16x32_bf16 v[224:227], v[200:203], v[104:107], v[224:227]
    ds_read_b64_tr_b16 v[188:189], v240 offset:36864
    ds_read_b64_tr_b16 v[190:191], v241 offset:36864
    v_mfma_f32_16x16x32_bf16 v[228:231], v[204:207], v[104:107], v[228:231]
    ds_read_b64_tr_b16 v[192:193], v240 offset:36896
    ds_read_b64_tr_b16 v[194:195], v241 offset:36896
    v_mfma_f32_16x16x32_bf16 v[232:235], v[208:211], v[104:107], v[232:235]
    ds_read_b64_tr_b16 v[196:197], v242 offset:36864
    ds_read_b64_tr_b16 v[198:199], v243 offset:36864
    s_waitcnt lgkmcnt(6)
    v_mfma_f32_16x16x32_bf16 v[224:227], v[212:215], v[108:111], v[224:227]
    ds_read_b64_tr_b16 v[200:201], v240 offset:39936
    ds_read_b64_tr_b16 v[202:203], v241 offset:39936
    v_mfma_f32_16x16x32_bf16 v[228:231], v[216:219], v[108:111], v[228:231]
    ds_read_b64_tr_b16 v[204:205], v240 offset:39968
    ds_read_b64_tr_b16 v[206:207], v241 offset:39968
    v_mfma_f32_16x16x32_bf16 v[232:235], v[220:223], v[108:111], v[232:235]
    ds_read_b64_tr_b16 v[208:209], v242 offset:39936
    ds_read_b64_tr_b16 v[210:211], v243 offset:39936
    s_waitcnt lgkmcnt(6)
    v_mfma_f32_16x16x32_bf16 v[224:227], v[188:191], v[112:115], v[224:227]
    ds_read_b64_tr_b16 v[212:213], v240 offset:43008
    ds_read_b64_tr_b16 v[214:215], v241 offset:43008
    v_mfma_f32_16x16x32_bf16 v[228:231], v[192:195], v[112:115], v[228:231]
    ds_read_b64_tr_b16 v[216:217], v240 offset:43040
    ds_read_b64_tr_b16 v[218:219], v241 offset:43040
    v_mfma_f32_16x16x32_bf16 v[232:235], v[196:199], v[112:115], v[232:235]
    ds_read_b64_tr_b16 v[220:221], v242 offset:43008
    ds_read_b64_tr_b16 v[222:223], v243 offset:43008
    s_waitcnt lgkmcnt(6)
    v_mfma_f32_16x16x32_bf16 v[224:227], v[200:203], v[116:119], v[224:227]
    ds_read_b64_tr_b16 v[188:189], v240 offset:46080
    ds_read_b64_tr_b16 v[190:191], v241 offset:46080
    v_mfma_f32_16x16x32_bf16 v[228:231], v[204:207], v[116:119], v[228:231]
    ds_read_b64_tr_b16 v[192:193], v240 offset:46112
    ds_read_b64_tr_b16 v[194:195], v241 offset:46112
    v_mfma_f32_16x16x32_bf16 v[232:235], v[208:211], v[116:119], v[232:235]
    ds_read_b64_tr_b16 v[196:197], v242 offset:46080
    ds_read_b64_tr_b16 v[198:199], v243 offset:46080
    s_waitcnt lgkmcnt(6)
    v_mfma_f32_16x16x32_bf16 v[224:227], v[212:215], v[120:123], v[224:227]
    ds_read_b64_tr_b16 v[200:201], v240 offset:49152
    ds_read_b64_tr_b16 v[202:203], v241 offset:49152
    v_mfma_f32_16x16x32_bf16 v[228:231], v[216:219], v[120:123], v[228:231]
    ds_read_b64_tr_b16 v[204:205], v240 offset:49184
    ds_read_b64_tr_b16 v[206:207], v241 offset:49184
    v_mfma_f32_16x16x32_bf16 v[232:235], v[220:223], v[120:123], v[232:235]
    ds_read_b64_tr_b16 v[208:209], v242 offset:49152
    ds_read_b64_tr_b16 v[210:211], v243 offset:49152
    s_waitcnt lgkmcnt(6)
    v_mfma_f32_16x16x32_bf16 v[224:227], v[188:191], v[124:127], v[224:227]
    ds_read_b64_tr_b16 v[212:213], v240 offset:52224
    ds_read_b64_tr_b16 v[214:215], v241 offset:52224
    v_mfma_f32_16x16x32_bf16 v[228:231], v[192:195], v[124:127], v[228:231]
    ds_read_b64_tr_b16 v[216:217], v240 offset:52256
    ds_read_b64_tr_b16 v[218:219], v241 offset:52256
    v_mfma_f32_16x16x32_bf16 v[232:235], v[196:199], v[124:127], v[232:235]
    ds_read_b64_tr_b16 v[220:221], v242 offset:52224
    ds_read_b64_tr_b16 v[222:223], v243 offset:52224
    s_waitcnt lgkmcnt(6)
    v_mfma_f32_16x16x32_bf16 v[224:227], v[200:203], v[128:131], v[224:227]
    v_mfma_f32_16x16x32_bf16 v[228:231], v[204:207], v[128:131], v[228:231]
    v_mfma_f32_16x16x32_bf16 v[232:235], v[208:211], v[128:131], v[232:235]
    s_waitcnt lgkmcnt(0)
    v_mfma_f32_16x16x32_bf16 v[224:227], v[212:215], v[132:135], v[224:227]
    v_mfma_f32_16x16x32_bf16 v[228:231], v[216:219], v[132:135], v[228:231]
    v_mfma_f32_16x16x32_bf16 v[232:235], v[220:223], v[132:135], v[232:235]
    s_mov_b32 s90, 0x3eae1a93
    s_mul_i32 s91, s84, 1280
    v_mul_u32_u24 v6, 80, v2
    s_add_u32 s91, s91, 137216
    s_xor_b32 s92, s84, 4
    s_mul_i32 s92, s92, 1280
    v_add_u32 v12, s91, v6
    s_add_u32 s92, s92, 137216
    v_lshl_add_u32 v7, v3, 3, v12
    s_sub_u32 s92, s92, s91
    v_and_b32 v8, 1, v3
    v_lshrrev_b32 v9, 1, v3
    v_mad_u32_u24 v8, v8, 36, v12
    v_lshl_add_u32 v9, v9, 4, v8
    v_mov_b32 v15, v232
    v_pk_mul_f32 v[224:225], s[90:91], v[224:225] op_sel_hi:[0,1]
    v_pk_mul_f32 v[226:227], s[90:91], v[226:227] op_sel_hi:[0,1]
    v_pk_mul_f32 v[228:229], s[90:91], v[228:229] op_sel_hi:[0,1]
    v_pk_mul_f32 v[230:231], s[90:91], v[230:231] op_sel_hi:[0,1]
    v_pk_mul_f32 v[232:233], s[90:91], v[232:233] op_sel_hi:[0,1]
    v_pk_mul_f32 v[234:235], s[90:91], v[234:235] op_sel_hi:[0,1]
    v_cvt_pk_bf16_f32 v48, v224, v225
    v_cvt_pk_bf16_f32 v49, v226, v227
    v_cvt_pk_bf16_f32 v50, v228, v229
    v_cvt_pk_bf16_f32 v51, v230, v231
    v_cvt_pk_bf16_f32 v52, v232, v233
    v_cvt_pk_bf16_f32 v53, v234, v235
    ds_write_b64 v7, v[48:49]
    ds_write_b64 v7, v[50:51] offset:32
    v_cmp_gt_u32 vcc, 16, v1
    s_nop 0
    s_and_saveexec_b64 s[96:97], vcc
    s_cbranch_execz L_skip_37
    ds_write_b64 v12, v[52:53] offset:64
L_skip_37:
    s_mov_b64 exec, s[96:97]
    v_cmp_eq_u32 vcc, 1, v3
    s_nop 0
    s_and_saveexec_b64 s[96:97], vcc
    s_cbranch_execz L_skip_38
    ds_write_b32 v12, v15 offset:72
L_skip_38:
    s_mov_b64 exec, s[96:97]
    v_add_u32 v14, s92, v9
    v_add_u32 v6, s92, v8
    s_waitcnt lgkmcnt(0)
    s_barrier
    s_cmp_lg_u32 s84, 0
    s_cbranch_scc1 L_nopre_39
    v_mov_b32 v162, 0
    v_lshlrev_b32 v163, 7, v1
    s_mov_b32 s93, 196608
    buffer_load_dword v160, v162, s[76:79], 0 offen sc1
    buffer_load_dword v161, v163, s[80:83], s93 offen sc1
L_nopre_39:
    ds_read2_b32 v[16:17], v9 offset0:0 offset1:1
    ds_read2_b32 v[18:19], v9 offset0:2 offset1:3
    ds_read2_b32 v[24:25], v14 offset0:0 offset1:1
    ds_read2_b32 v[26:27], v14 offset0:2 offset1:3
    ds_read_b32 v10, v8 offset:32
    ds_read_b32 v13, v6 offset:32
    ds_read_b32 v11, v12 offset:72
    v_cmp_gt_u32 vcc, 32, v1
    v_mov_b32 v21, 0
    v_mov_b32 v22, 0
    v_mov_b32 v29, 0
    v_mov_b32 v30, 0
    s_waitcnt lgkmcnt(0)
    v_cndmask_b32 v20, 0, v10, vcc
    v_cndmask_b32 v23, 0, v10, vcc
    v_cndmask_b32 v28, 0, v13, vcc
    v_cndmask_b32 v31, 0, v13, vcc
    v_mov_b32 v4, v11
    v_mov_b64 v[52:53], 0
    v_mov_b64 v[54:55], 0
    v_mov_b64 v[56:57], 0
    v_mov_b64 v[58:59], 0
    v_mov_b64 v[60:61], 0
    v_mov_b64 v[62:63], 0
    v_mov_b64 v[64:65], 0
    v_mov_b64 v[66:67], 0
    v_mov_b64 v[68:69], 0
    v_mov_b64 v[70:71], 0
    v_mov_b64 v[72:73], 0
    v_mov_b64 v[74:75], 0
    v_mov_b64 v[76:77], 0
    v_mov_b64 v[78:79], 0
    v_mov_b64 v[80:81], 0
    v_mov_b64 v[82:83], 0
    v_mov_b64 v[108:109], 0
    v_mov_b64 v[140:141], 0
    v_mov_b64 v[110:111], 0
    v_mov_b64 v[142:143], 0
    v_mov_b64 v[112:113], 0
    v_mov_b64 v[144:145], 0
    v_mov_b64 v[114:115], 0
    v_mov_b64 v[146:147], 0
    v_mov_b64 v[48:49], 0
    v_mov_b64 v[50:51], 0
    s_cmp_lg_u32 s84, 0
    s_cbranch_scc1 L_s1_nw_40
    s_waitcnt vmcnt(0)
    v_cmp_ne_u32 vcc, v160, v161
    v_readfirstlane_b32 s88, v160
    v_mov_b32 v6, v160
    s_cmp_eq_u32 s88, 0
    s_cbranch_scc1 L_s1_no_42
    s_cbranch_vccz L_s1_got_41
L_s1_no_42:
    v_mov_b32 v7, 0
    v_lshlrev_b32 v8, 7, v1
    s_mov_b32 s90, 196608
    s_mov_b32 s3, 400000
L_s1_44:
    buffer_load_dword v6, v7, s[76:79], 0 offen sc1
    buffer_load_dword v9, v8, s[80:83], s90 offen sc1
    s_waitcnt vmcnt(0)
    v_cmp_ne_u32 vcc, v6, v9
    v_readfirstlane_b32 s88, v6
    s_nop 0
    s_cmp_eq_u32 s88, 0
    s_cbranch_scc1 L_s1_again_43
    s_cbranch_vccz L_s1_done_45
L_s1_again_43:
    s_sub_u32 s3, s3, 1
    s_cbranch_scc1 L_s1_done_45
    s_branch L_s1_44
L_s1_done_45:
L_s1_got_41:
    v_mov_b32 v7, 156672
    ds_write_b32 v7, v6
    s_waitcnt lgkmcnt(0)
L_s1_nw_40:
    s_barrier
    v_mov_b32 v9, 156672
    s_mov_b32 s90, 155648
    buffer_load_dwordx4 v[12:15], v5, s[80:83], s90 offen sc1
    ds_read_b32 v9, v9
    s_lshl_b32 s95, s50, 10
    s_lshl_b32 s91, s48, 12
    s_add_u32 s90, s95, s91
    s_add_u32 s90, s90, 65536
    s_mov_b32 m0, s90
    s_lshl_b32 s92, s48, 15
    buffer_load_dwordx4 v5, s[80:83], s90 offen sc1 lds
    s_add_u32 s90, s92, s95
    s_mov_b32 m0, s90
    s_mul_i32 s93, s48, 40960
    buffer_load_dwordx4 v5, s[80:83], s90 offen sc1 lds
    s_add_u32 s93, s93, 73728
    s_add_u32 s91, s93, s95
    s_mov_b32 m0, s91
    s_add_u32 s90, s90, 4096
    buffer_load_dwordx4 v5, s[80:83], s91 offen sc1 lds
    s_mov_b32 m0, s90
    s_add_u32 s91, s91, 4096
    buffer_load_dwordx4 v5, s[80:83], s90 offen sc1 lds
    s_mov_b32 m0, s91
    s_mul_i32 s95, s50, 6144
    buffer_load_dwordx4 v5, s[80:83], s91 offen sc1 lds
    s_add_u32 s64, s92, s95
    s_add_u32 s64, s64, 8192
    s_lshl_b32 s95, s50, 13
    s_add_u32 s66, s93, s95
    s_add_u32 s66, s66, 8192
    s_add_u32 s65, s64, 4096
    s_add_u32 s67, s66, 4096
    s_waitcnt vmcnt(5)
    v_min_u32 v6, v12, v14
    v_max_u32 v10, v12, v14
    v_max3_u32 v11, v13, v15, v6
    s_nop 0
    v_min_u32_dpp v14, v10, v10 row_ror:8 row_mask:0xf bank_mask:0xf
    v_max_u32_dpp v13, v11, v11 row_ror:8 row_mask:0xf bank_mask:0xf
    v_max_u32_dpp v10, v10, v10 row_ror:8 row_mask:0xf bank_mask:0xf
    v_max_u32 v11, v13, v14
    s_nop 0
    v_min_u32_dpp v14, v10, v10 row_ror:4 row_mask:0xf bank_mask:0xf
    v_max_u32_dpp v13, v11, v11 row_ror:4 row_mask:0xf bank_mask:0xf
    v_max_u32_dpp v10, v10, v10 row_ror:4 row_mask:0xf bank_mask:0xf
    v_max_u32 v11, v13, v14
    s_nop 0
    v_min_u32_dpp v14, v10, v10 row_ror:2 row_mask:0xf bank_mask:0xf
    v_max_u32_dpp v13, v11, v11 row_ror:2 row_mask:0xf bank_mask:0xf
    v_max_u32_dpp v10, v10, v10 row_ror:2 row_mask:0xf bank_mask:0xf
    v_max_u32 v11, v13, v14
    s_nop 0
    v_min_u32_dpp v14, v10, v10 row_ror:1 row_mask:0xf bank_mask:0xf
    v_max_u32_dpp v13, v11, v11 row_ror:1 row_mask:0xf bank_mask:0xf
    v_max_u32_dpp v10, v10, v10 row_ror:1 row_mask:0xf bank_mask:0xf
    v_max_u32 v11, v13, v14
    v_readlane_b32 s100, v10, 0
    v_readlane_b32 s101, v11, 0
    v_readlane_b32 s90, v10, 16
    v_readlane_b32 s91, v11, 16
    s_min_u32 s92, s100, s90
    s_max_u32 s100, s100, s90
    s_max_u32 s101, s101, s91
    s_max_u32 s101, s101, s92
    v_readlane_b32 s90, v10, 32
    v_readlane_b32 s91, v11, 32
    s_min_u32 s92, s100, s90
    s_max_u32 s100, s100, s90
    s_max_u32 s101, s101, s91
    s_max_u32 s101, s101, s92
    v_readlane_b32 s90, v10, 48
    v_readlane_b32 s91, v11, 48
    s_min_u32 s92, s100, s90
    s_max_u32 s100, s100, s90
    s_max_u32 s101, s101, s91
    s_max_u32 s101, s101, s92
    s_andn2_b32 s98, 0x7ff, s100
    s_andn2_b32 s99, 0x7ff, s101
    s_cmp_lt_u32 s86, 4
    s_cbranch_scc1 L_att_role_46
    s_mul_i32 s90, s98, 1152
    s_mul_i32 s91, s99, 1152
    v_and_b32 v8, 2, v1
    v_mov_b32 v6, s90
    v_cmp_eq_u32 vcc, 0, v8
    v_mov_b32 v7, s91
    s_mul_i32 s90, s84, 144
    v_cndmask_b32 v6, v7, v6, vcc
    v_lshl_add_u32 v6, v3, 2, v6
    buffer_load_dword v184, v6, s[32:35], s90 offen offset:0
    buffer_load_dword v185, v6, s[32:35], s90 offen offset:16
    buffer_load_dword v186, v6, s[32:35], s90 offen offset:32
    buffer_load_dword v187, v6, s[32:35], s90 offen offset:48
    buffer_load_dword v188, v6, s[32:35], s90 offen offset:64
    buffer_load_dword v189, v6, s[32:35], s90 offen offset:80
    buffer_load_dword v190, v6, s[32:35], s90 offen offset:96
    buffer_load_dword v191, v6, s[32:35], s90 offen offset:112
    buffer_load_dword v192, v6, s[32:35], s90 offen offset:128
    s_waitcnt vmcnt(9) lgkmcnt(0)
    v_readfirstlane_b32 s88, v9
    s_barrier
    ds_read_b128 v[36:39], v33
    ds_read_b128 v[40:43], v34
    ds_read_b128 v[44:47], v35
    s_waitcnt lgkmcnt(1)
    v_mfma_f32_32x32x16_bf16 v[84:99], v[36:39], v[16:19], 0
    v_mfma_f32_32x32x16_bf16 v[116:131], v[36:39], v[24:27], 0
    ds_read_b128 v[36:39], v33 offset:1024
    v_min_u32 v6, 11, v2
    v_mul_u32_u24 v7, 18432, v3
    s_mul_i32 s29, s84, 663552
    v_lshl_add_u32 v6, v6, 2, v7
    s_mul_i32 s91, s89, 48
    v_add_u32 v7, 9216, v6
    s_add_u32 s29, s29, s91
    s_nop 0
    v_mfma_f32_32x32x8_bf16 v[84:99], v[40:41], v[20:21], v[84:99]
    v_mfma_f32_32x32x8_bf16 v[116:131], v[40:41], v[28:29], v[116:131]
    s_waitcnt lgkmcnt(0)
    s_cmp_eq_u32 s48, 0
    s_cbranch_scc1 L_p0_48
    s_setprio 1
    s_branch L_p1_49
L_p0_48:
    s_setprio 0
L_p1_49:
    s_nop 9
    .p2align 6
    v_smfmac_f32_32x32x32_bf16 v[52:67], v[48:51], v[108:115], v32
    v_exp_f32 v84, v84
    v_exp_f32 v85, v85
    s_mov_b32 m0, s64
    v_exp_f32 v86, v86
    v_exp_f32 v87, v87
    v_smfmac_f32_32x32x32_bf16 v[68:83], v[48:51], v[140:147], v32
    ds_read_b128 v[48:51], v35 offset:640
    v_exp_f32 v88, v88
    v_exp_f32 v89, v89
    buffer_load_dwordx4 v5, s[80:83], s64 offen sc1 lds
    v_exp_f32 v90, v90
    v_exp_f32 v91, v91
    v_mfma_f32_32x32x16_bf16 v[100:115], v[36:39], v[16:19], 0
    v_exp_f32 v92, v92
    v_exp_f32 v93, v93
    buffer_load_dwordx4 v5, s[80:83], s64 offen offset:1024 sc1 lds
    v_exp_f32 v94, v94
    v_exp_f32 v95, v95
    v_mfma_f32_32x32x16_bf16 v[132:147], v[36:39], v[24:27], 0
    ds_read_b128 v[36:39], v33 offset:2048
    v_exp_f32 v96, v96
    v_exp_f32 v97, v97
    buffer_load_dwordx4 v5, s[80:83], s64 offen offset:2048 sc1 lds
    v_exp_f32 v98, v98
    v_exp_f32 v99, v99
    v_mfma_f32_32x32x8_bf16 v[100:115], v[40:41], v[22:23], v[100:115]
    v_exp_f32 v116, v116
    v_exp_f32 v117, v117
    buffer_load_dwordx4 v5, s[80:83], s64 offen offset:3072 sc1 lds
    v_exp_f32 v118, v118
    v_exp_f32 v119, v119
    v_mfma_f32_32x32x8_bf16 v[132:147], v[40:41], v[30:31], v[132:147]
    v_exp_f32 v120, v120
    v_exp_f32 v121, v121
    s_mov_b32 m0, s66
    v_exp_f32 v122, v122
    v_exp_f32 v123, v123
    s_waitcnt lgkmcnt(2)
    v_smfmac_f32_32x32x32_bf16 v[52:67], v[44:47], v[84:91], v32
    v_exp_f32 v124, v124
    v_exp_f32 v125, v125
    buffer_load_dwordx4 v5, s[80:83], s66 offen sc1 lds
    v_exp_f32 v126, v126
    v_exp_f32 v127, v127
    v_smfmac_f32_32x32x32_bf16 v[68:83], v[44:47], v[116:123], v32
    ds_read_b128 v[44:47], v35 offset:1280
    v_exp_f32 v128, v128
    v_exp_f32 v129, v129
    buffer_load_dwordx4 v5, s[80:83], s66 offen offset:1024 sc1 lds
    v_exp_f32 v130, v130
    v_exp_f32 v131, v131
    s_waitcnt lgkmcnt(1)
    v_smfmac_f32_32x32x32_bf16 v[52:67], v[48:51], v[92:99], v32
    v_exp_f32 v100, v100
    v_exp_f32 v101, v101
    buffer_load_dwordx4 v5, s[80:83], s66 offen offset:2048 sc1 lds
    v_exp_f32 v102, v102
    v_exp_f32 v103, v103
    v_smfmac_f32_32x32x32_bf16 v[68:83], v[48:51], v[124:131], v32
    ds_read_b128 v[48:51], v35 offset:1920
    v_exp_f32 v104, v104
    v_exp_f32 v105, v105
    buffer_load_dwordx4 v5, s[80:83], s66 offen offset:3072 sc1 lds
    v_exp_f32 v106, v106
    v_exp_f32 v107, v107
    v_mfma_f32_32x32x16_bf16 v[84:99], v[36:39], v[16:19], 0
    v_exp_f32 v108, v108
    v_exp_f32 v109, v109
    s_mov_b32 m0, s65
    v_exp_f32 v110, v110
    v_exp_f32 v111, v111
    v_mfma_f32_32x32x16_bf16 v[116:131], v[36:39], v[24:27], 0
    ds_read_b128 v[36:39], v33 offset:3072
    v_exp_f32 v112, v112
    v_exp_f32 v113, v113
    buffer_load_dwordx4 v5, s[80:83], s65 offen sc1 lds
    v_exp_f32 v114, v114
    v_exp_f32 v115, v115
    v_mfma_f32_32x32x8_bf16 v[84:99], v[42:43], v[20:21], v[84:99]
    v_exp_f32 v132, v132
    v_exp_f32 v133, v133
    buffer_load_dwordx4 v5, s[80:83], s65 offen offset:1024 sc1 lds
    v_exp_f32 v134, v134
    v_exp_f32 v135, v135
    v_mfma_f32_32x32x8_bf16 v[116:131], v[42:43], v[28:29], v[116:131]
    v_exp_f32 v136, v136
    v_exp_f32 v137, v137
    s_mov_b32 m0, s67
    v_exp_f32 v138, v138
    v_exp_f32 v139, v139
    s_waitcnt lgkmcnt(2)
    v_smfmac_f32_32x32x32_bf16 v[52:67], v[44:47], v[100:107], v32
    v_exp_f32 v140, v140
    v_exp_f32 v141, v141
    buffer_load_dwordx4 v5, s[80:83], s67 offen sc1 lds
    v_exp_f32 v142, v142
    v_exp_f32 v143, v143
    v_smfmac_f32_32x32x32_bf16 v[68:83], v[44:47], v[132:139], v32
    ds_read_b128 v[44:47], v35 offset:2560
    v_exp_f32 v144, v144
    v_exp_f32 v145, v145
    buffer_load_dwordx4 v5, s[80:83], s67 offen offset:1024 sc1 lds
    v_exp_f32 v146, v146
    v_exp_f32 v147, v147
    s_waitcnt lgkmcnt(1)
    v_smfmac_f32_32x32x32_bf16 v[52:67], v[48:51], v[108:115], v32
    v_exp_f32 v84, v84
    v_exp_f32 v85, v85
    buffer_load_dwordx4 v5, s[80:83], s67 offen offset:2048 sc1 lds
    v_exp_f32 v86, v86
    v_exp_f32 v87, v87
    v_smfmac_f32_32x32x32_bf16 v[68:83], v[48:51], v[140:147], v32
    ds_read_b128 v[48:51], v35 offset:3200
    v_exp_f32 v88, v88
    v_exp_f32 v89, v89
    buffer_load_dwordx4 v5, s[80:83], s67 offen offset:3072 sc1 lds
    v_exp_f32 v90, v90
    v_exp_f32 v91, v91
    v_mfma_f32_32x32x16_bf16 v[100:115], v[36:39], v[16:19], 0
    v_exp_f32 v92, v92
    v_exp_f32 v93, v93
    buffer_load_dword v148, v6, s[52:55], s29 offen
    v_exp_f32 v94, v94
    v_exp_f32 v95, v95
    v_mfma_f32_32x32x16_bf16 v[132:147], v[36:39], v[24:27], 0
    ds_read_b128 v[36:39], v33 offset:4096
    v_exp_f32 v96, v96
    v_exp_f32 v97, v97
    v_exp_f32 v98, v98
    v_exp_f32 v99, v99
    buffer_load_dword v150, v6, s[56:59], s29 offen
    v_mfma_f32_32x32x8_bf16 v[100:115], v[42:43], v[22:23], v[100:115]
    v_exp_f32 v116, v116
    v_exp_f32 v117, v117
    v_exp_f32 v118, v118
    v_exp_f32 v119, v119
    v_mfma_f32_32x32x8_bf16 v[132:147], v[42:43], v[30:31], v[132:147]
    ds_read_b128 v[40:43], v34 offset:512
    v_exp_f32 v120, v120
    v_exp_f32 v121, v121
    v_exp_f32 v122, v122
    v_exp_f32 v123, v123
    buffer_load_dword v149, v7, s[52:55], s29 offen
    s_waitcnt lgkmcnt(3)
    v_smfmac_f32_32x32x32_bf16 v[52:67], v[44:47], v[84:91], v32
    v_exp_f32 v124, v124
    v_exp_f32 v125, v125
    v_exp_f32 v126, v126
    v_exp_f32 v127, v127
    v_smfmac_f32_32x32x32_bf16 v[68:83], v[44:47], v[116:123], v32
    ds_read_b128 v[44:47], v35 offset:3840
    v_exp_f32 v128, v128
    v_exp_f32 v129, v129
    v_exp_f32 v130, v130
    v_exp_f32 v131, v131
    buffer_load_dword v151, v7, s[56:59], s29 offen
    s_waitcnt lgkmcnt(1)
    v_smfmac_f32_32x32x32_bf16 v[52:67], v[48:51], v[92:99], v32
    v_exp_f32 v100, v100
    v_exp_f32 v101, v101
    v_exp_f32 v102, v102
    v_exp_f32 v103, v103
    v_smfmac_f32_32x32x32_bf16 v[68:83], v[48:51], v[124:131], v32
    ds_read_b128 v[48:51], v35 offset:4480
    v_exp_f32 v104, v104
    v_exp_f32 v105, v105
    v_exp_f32 v106, v106
    v_exp_f32 v107, v107
    s_add_u32 s29, s29, 73728
    v_mfma_f32_32x32x16_bf16 v[84:99], v[36:39], v[16:19], 0
    v_exp_f32 v108, v108
    v_exp_f32 v109, v109
    v_exp_f32 v110, v110
    v_exp_f32 v111, v111
    v_mfma_f32_32x32x16_bf16 v[116:131], v[36:39], v[24:27], 0
    ds_read_b128 v[36:39], v33 offset:5120
    v_exp_f32 v112, v112
    v_exp_f32 v113, v113
    v_exp_f32 v114, v114
    v_exp_f32 v115, v115
    buffer_load_dword v152, v6, s[52:55], s29 offen
    v_mfma_f32_32x32x8_bf16 v[84:99], v[40:41], v[20:21], v[84:99]
    v_exp_f32 v132, v132
    v_exp_f32 v133, v133
    v_exp_f32 v134, v134
    v_exp_f32 v135, v135
    v_mfma_f32_32x32x8_bf16 v[116:131], v[40:41], v[28:29], v[116:131]
    v_exp_f32 v136, v136
    v_exp_f32 v137, v137
    v_exp_f32 v138, v138
    v_exp_f32 v139, v139
    buffer_load_dword v154, v6, s[56:59], s29 offen
    s_waitcnt lgkmcnt(2)
    v_smfmac_f32_32x32x32_bf16 v[52:67], v[44:47], v[100:107], v32
    v_exp_f32 v140, v140
    v_exp_f32 v141, v141
    v_exp_f32 v142, v142
    v_exp_f32 v143, v143
    v_smfmac_f32_32x32x32_bf16 v[68:83], v[44:47], v[132:139], v32
    ds_read_b128 v[44:47], v35 offset:5120
    v_exp_f32 v144, v144
    v_exp_f32 v145, v145
    buffer_load_dword v153, v7, s[52:55], s29 offen
    v_exp_f32 v146, v146
    v_exp_f32 v147, v147
    s_waitcnt lgkmcnt(1)
    v_smfmac_f32_32x32x32_bf16 v[52:67], v[48:51], v[108:115], v32
    v_exp_f32 v84, v84
    v_exp_f32 v85, v85
    v_exp_f32 v86, v86
    v_exp_f32 v87, v87
    v_smfmac_f32_32x32x32_bf16 v[68:83], v[48:51], v[140:147], v32
    ds_read_b128 v[48:51], v35 offset:5760
    v_exp_f32 v88, v88
    v_exp_f32 v89, v89
    buffer_load_dword v155, v7, s[56:59], s29 offen
    v_exp_f32 v90, v90
    v_exp_f32 v91, v91
    v_mfma_f32_32x32x16_bf16 v[100:115], v[36:39], v[16:19], 0
    v_exp_f32 v92, v92
    v_exp_f32 v93, v93
    v_exp_f32 v94, v94
    v_exp_f32 v95, v95
    v_mfma_f32_32x32x16_bf16 v[132:147], v[36:39], v[24:27], 0
    ds_read_b128 v[36:39], v33 offset:6144
    v_exp_f32 v96, v96
    v_exp_f32 v97, v97
    s_add_u32 s29, s29, 73728
    v_exp_f32 v98, v98
    v_exp_f32 v99, v99
    v_mfma_f32_32x32x8_bf16 v[100:115], v[40:41], v[22:23], v[100:115]
    v_exp_f32 v116, v116
    v_exp_f32 v117, v117
    v_exp_f32 v118, v118
    v_exp_f32 v119, v119
    v_mfma_f32_32x32x8_bf16 v[132:147], v[40:41], v[30:31], v[132:147]
    v_exp_f32 v120, v120
    v_exp_f32 v121, v121
    buffer_load_dword v156, v6, s[52:55], s29 offen
    v_exp_f32 v122, v122
    v_exp_f32 v123, v123
    s_waitcnt lgkmcnt(2)
    v_smfmac_f32_32x32x32_bf16 v[52:67], v[44:47], v[84:91], v32
    v_exp_f32 v124, v124
    v_exp_f32 v125, v125
    v_exp_f32 v126, v126
    v_exp_f32 v127, v127
    v_smfmac_f32_32x32x32_bf16 v[68:83], v[44:47], v[116:123], v32
    ds_read_b128 v[44:47], v35 offset:6400
    v_exp_f32 v128, v128
    v_exp_f32 v129, v129
    s_waitcnt vmcnt(9)
    s_barrier
    buffer_load_dword v158, v6, s[56:59], s29 offen
    v_exp_f32 v130, v130
    v_exp_f32 v131, v131
    s_waitcnt lgkmcnt(1)
    v_smfmac_f32_32x32x32_bf16 v[52:67], v[48:51], v[92:99], v32
    v_exp_f32 v100, v100
    v_exp_f32 v101, v101
    v_exp_f32 v102, v102
    v_exp_f32 v103, v103
    v_smfmac_f32_32x32x32_bf16 v[68:83], v[48:51], v[124:131], v32
    ds_read_b128 v[48:51], v35 offset:7040
    v_exp_f32 v104, v104
    v_exp_f32 v105, v105
    buffer_load_dword v157, v7, s[52:55], s29 offen
    v_exp_f32 v106, v106
    v_exp_f32 v107, v107
    v_mfma_f32_32x32x16_bf16 v[84:99], v[36:39], v[16:19], 0
    v_exp_f32 v108, v108
    v_exp_f32 v109, v109
    v_exp_f32 v110, v110
    v_exp_f32 v111, v111
    buffer_load_dword v159, v7, s[56:59], s29 offen
    v_mfma_f32_32x32x16_bf16 v[116:131], v[36:39], v[24:27], 0
    ds_read_b128 v[36:39], v33 offset:7168
    v_exp_f32 v112, v112
    v_exp_f32 v113, v113
    v_exp_f32 v114, v114
    v_exp_f32 v115, v115
    v_mfma_f32_32x32x8_bf16 v[84:99], v[42:43], v[20:21], v[84:99]
    v_exp_f32 v132, v132
    v_exp_f32 v133, v133
    v_exp_f32 v134, v134
    v_exp_f32 v135, v135
    s_add_u32 s29, s29, 73728
    v_mfma_f32_32x32x8_bf16 v[116:131], v[42:43], v[28:29], v[116:131]
    v_exp_f32 v136, v136
    v_exp_f32 v137, v137
    v_exp_f32 v138, v138
    v_exp_f32 v139, v139
    s_waitcnt lgkmcnt(2)
    v_smfmac_f32_32x32x32_bf16 v[52:67], v[44:47], v[100:107], v32
    v_exp_f32 v140, v140
    v_exp_f32 v141, v141
    v_exp_f32 v142, v142
    v_exp_f32 v143, v143
    buffer_load_dword v160, v6, s[52:55], s29 offen
    v_smfmac_f32_32x32x32_bf16 v[68:83], v[44:47], v[132:139], v32
    ds_read_b128 v[44:47], v35 offset:7680
    v_exp_f32 v144, v144
    v_exp_f32 v145, v145
    v_exp_f32 v146, v146
    v_exp_f32 v147, v147
    s_waitcnt lgkmcnt(1)
    v_smfmac_f32_32x32x32_bf16 v[52:67], v[48:51], v[108:115], v32
    v_exp_f32 v84, v84
    v_exp_f32 v85, v85
    v_exp_f32 v86, v86
    v_exp_f32 v87, v87
    buffer_load_dword v162, v6, s[56:59], s29 offen
    v_smfmac_f32_32x32x32_bf16 v[68:83], v[48:51], v[140:147], v32
    ds_read_b128 v[48:51], v35 offset:8320
    v_exp_f32 v88, v88
    v_exp_f32 v89, v89
    v_exp_f32 v90, v90
    v_exp_f32 v91, v91
    v_mfma_f32_32x32x16_bf16 v[100:115], v[36:39], v[16:19], 0
    v_exp_f32 v92, v92
    v_exp_f32 v93, v93
    v_exp_f32 v94, v94
    v_exp_f32 v95, v95
    buffer_load_dword v161, v7, s[52:55], s29 offen
    v_mfma_f32_32x32x16_bf16 v[132:147], v[36:39], v[24:27], 0
    ds_read_b128 v[36:39], v33 offset:8192
    v_exp_f32 v96, v96
    v_exp_f32 v97, v97
    v_exp_f32 v98, v98
    v_exp_f32 v99, v99
    v_mfma_f32_32x32x8_bf16 v[100:115], v[42:43], v[22:23], v[100:115]
    v_exp_f32 v116, v116
    v_exp_f32 v117, v117
    v_exp_f32 v118, v118
    v_exp_f32 v119, v119
    buffer_load_dword v163, v7, s[56:59], s29 offen
    v_mfma_f32_32x32x8_bf16 v[132:147], v[42:43], v[30:31], v[132:147]
    ds_read_b128 v[40:43], v34 offset:1024
    v_exp_f32 v120, v120
    v_exp_f32 v121, v121
    v_exp_f32 v122, v122
    v_exp_f32 v123, v123
    s_waitcnt lgkmcnt(3)
    v_smfmac_f32_32x32x32_bf16 v[52:67], v[44:47], v[84:91], v32
    v_exp_f32 v124, v124
    v_exp_f32 v125, v125
    s_add_u32 s29, s29, 73728
    v_exp_f32 v126, v126
    v_exp_f32 v127, v127
    v_smfmac_f32_32x32x32_bf16 v[68:83], v[44:47], v[116:123], v32
    ds_read_b128 v[44:47], v35 offset:8960
    v_exp_f32 v128, v128
    v_exp_f32 v129, v129
    v_exp_f32 v130, v130
    v_exp_f32 v131, v131
    s_waitcnt lgkmcnt(1)
    v_smfmac_f32_32x32x32_bf16 v[52:67], v[48:51], v[92:99], v32
    v_exp_f32 v100, v100
    v_exp_f32 v101, v101
    buffer_load_dword v164, v6, s[52:55], s29 offen
    v_exp_f32 v102, v102
    v_exp_f32 v103, v103
    v_smfmac_f32_32x32x32_bf16 v[68:83], v[48:51], v[124:131], v32
    ds_read_b128 v[48:51], v35 offset:9600
    v_exp_f32 v104, v104
    v_exp_f32 v105, v105
    v_exp_f32 v106, v106
    v_exp_f32 v107, v107
    v_mfma_f32_32x32x16_bf16 v[84:99], v[36:39], v[16:19], 0
    v_exp_f32 v108, v108
    v_exp_f32 v109, v109
    buffer_load_dword v166, v6, s[56:59], s29 offen
    v_exp_f32 v110, v110
    v_exp_f32 v111, v111
    v_mfma_f32_32x32x16_bf16 v[116:131], v[36:39], v[24:27], 0
    ds_read_b128 v[36:39], v33 offset:9216
    v_exp_f32 v112, v112
    v_exp_f32 v113, v113
    v_exp_f32 v114, v114
    v_exp_f32 v115, v115
    v_mfma_f32_32x32x8_bf16 v[84:99], v[40:41], v[20:21], v[84:99]
    v_exp_f32 v132, v132
    v_exp_f32 v133, v133
    buffer_load_dword v165, v7, s[52:55], s29 offen
    v_exp_f32 v134, v134
    v_exp_f32 v135, v135
    v_mfma_f32_32x32x8_bf16 v[116:131], v[40:41], v[28:29], v[116:131]
    v_exp_f32 v136, v136
    v_exp_f32 v137, v137
    v_exp_f32 v138, v138
    v_exp_f32 v139, v139
    s_waitcnt lgkmcnt(2)
    v_smfmac_f32_32x32x32_bf16 v[52:67], v[44:47], v[100:107], v32
    v_exp_f32 v140, v140
    v_exp_f32 v141, v141
    buffer_load_dword v167, v7, s[56:59], s29 offen
    v_exp_f32 v142, v142
    v_exp_f32 v143, v143
    v_smfmac_f32_32x32x32_bf16 v[68:83], v[44:47], v[132:139], v32
    ds_read_b128 v[44:47], v35 offset:10240
    v_exp_f32 v144, v144
    v_exp_f32 v145, v145
    v_exp_f32 v146, v146
    v_exp_f32 v147, v147
    v_add_u32 v33, 8192, v33
    v_add_u32 v34, 1024, v34
    v_add_u32 v35, 10240, v35
    s_waitcnt lgkmcnt(1)
    s_cmp_eq_u32 s48, 1
    s_cbranch_scc1 L_p0_50
    s_setprio 1
    s_branch L_p1_51
L_p0_50:
    s_setprio 0
L_p1_51:
    s_nop 3
    v_smfmac_f32_32x32x32_bf16 v[52:67], v[48:51], v[108:115], v32
    v_exp_f32 v84, v84
    v_exp_f32 v85, v85
    s_add_u32 s29, s29, 73728
    v_exp_f32 v86, v86
    v_exp_f32 v87, v87
    v_smfmac_f32_32x32x32_bf16 v[68:83], v[48:51], v[140:147], v32
    ds_read_b128 v[48:51], v35 offset:640
    v_exp_f32 v88, v88
    v_exp_f32 v89, v89
    v_exp_f32 v90, v90
    v_exp_f32 v91, v91
    v_mfma_f32_32x32x16_bf16 v[100:115], v[36:39], v[16:19], 0
    v_exp_f32 v92, v92
    v_exp_f32 v93, v93
    v_exp_f32 v94, v94
    v_exp_f32 v95, v95
    buffer_load_dword v168, v6, s[52:55], s29 offen
    v_mfma_f32_32x32x16_bf16 v[132:147], v[36:39], v[24:27], 0
    ds_read_b128 v[36:39], v33 offset:2048
    v_exp_f32 v96, v96
    v_exp_f32 v97, v97
    v_exp_f32 v98, v98
    v_exp_f32 v99, v99
    v_mfma_f32_32x32x8_bf16 v[100:115], v[40:41], v[22:23], v[100:115]
    v_exp_f32 v116, v116
    v_exp_f32 v117, v117
    v_exp_f32 v118, v118
    v_exp_f32 v119, v119
    v_mfma_f32_32x32x8_bf16 v[132:147], v[40:41], v[30:31], v[132:147]
    v_exp_f32 v120, v120
    v_exp_f32 v121, v121
    v_exp_f32 v122, v122
    v_exp_f32 v123, v123
    buffer_load_dword v170, v6, s[56:59], s29 offen
    s_waitcnt lgkmcnt(2)
    v_smfmac_f32_32x32x32_bf16 v[52:67], v[44:47], v[84:91], v32
    v_exp_f32 v124, v124
    v_exp_f32 v125, v125
    v_exp_f32 v126, v126
    v_exp_f32 v127, v127
    v_smfmac_f32_32x32x32_bf16 v[68:83], v[44:47], v[116:123], v32
    ds_read_b128 v[44:47], v35 offset:1280
    v_exp_f32 v128, v128
    v_exp_f32 v129, v129
    v_exp_f32 v130, v130
    v_exp_f32 v131, v131
    s_waitcnt lgkmcnt(1)
    v_smfmac_f32_32x32x32_bf16 v[52:67], v[48:51], v[92:99], v32
    v_exp_f32 v100, v100
    v_exp_f32 v101, v101
    v_exp_f32 v102, v102
    v_exp_f32 v103, v103
    buffer_load_dword v169, v7, s[52:55], s29 offen
    v_smfmac_f32_32x32x32_bf16 v[68:83], v[48:51], v[124:131], v32
    ds_read_b128 v[48:51], v35 offset:1920
    v_exp_f32 v104, v104
    v_exp_f32 v105, v105
    v_exp_f32 v106, v106
    v_exp_f32 v107, v107
    v_mfma_f32_32x32x16_bf16 v[84:99], v[36:39], v[16:19], 0
    v_exp_f32 v108, v108
    v_exp_f32 v109, v109
    v_exp_f32 v110, v110
    v_exp_f32 v111, v111
    v_mfma_f32_32x32x16_bf16 v[116:131], v[36:39], v[24:27], 0
    ds_read_b128 v[36:39], v33 offset:3072
    v_exp_f32 v112, v112
    v_exp_f32 v113, v113
    v_exp_f32 v114, v114
    v_exp_f32 v115, v115
    buffer_load_dword v171, v7, s[56:59], s29 offen
    v_mfma_f32_32x32x8_bf16 v[84:99], v[42:43], v[20:21], v[84:99]
    v_exp_f32 v132, v132
    v_exp_f32 v133, v133
    v_exp_f32 v134, v134
    v_exp_f32 v135, v135
    v_mfma_f32_32x32x8_bf16 v[116:131], v[42:43], v[28:29], v[116:131]
    v_exp_f32 v136, v136
    v_exp_f32 v137, v137
    v_exp_f32 v138, v138
    v_exp_f32 v139, v139
    s_waitcnt lgkmcnt(2)
    v_smfmac_f32_32x32x32_bf16 v[52:67], v[44:47], v[100:107], v32
    v_exp_f32 v140, v140
    v_exp_f32 v141, v141
    v_exp_f32 v142, v142
    v_exp_f32 v143, v143
    s_add_u32 s29, s29, 73728
    v_smfmac_f32_32x32x32_bf16 v[68:83], v[44:47], v[132:139], v32
    ds_read_b128 v[44:47], v35 offset:2560
    v_exp_f32 v144, v144
    v_exp_f32 v145, v145
    v_exp_f32 v146, v146
    v_exp_f32 v147, v147
    s_waitcnt lgkmcnt(1)
    v_smfmac_f32_32x32x32_bf16 v[52:67], v[48:51], v[108:115], v32
    v_exp_f32 v84, v84
    v_exp_f32 v85, v85
    v_exp_f32 v86, v86
    v_exp_f32 v87, v87
    v_smfmac_f32_32x32x32_bf16 v[68:83], v[48:51], v[140:147], v32
    ds_read_b128 v[48:51], v35 offset:3200
    v_exp_f32 v88, v88
    v_exp_f32 v89, v89
    v_exp_f32 v90, v90
    v_exp_f32 v91, v91
    buffer_load_dword v172, v6, s[52:55], s29 offen
    v_mfma_f32_32x32x16_bf16 v[100:115], v[36:39], v[16:19], 0
    v_exp_f32 v92, v92
    v_exp_f32 v93, v93
    v_exp_f32 v94, v94
    v_exp_f32 v95, v95
    v_mfma_f32_32x32x16_bf16 v[132:147], v[36:39], v[24:27], 0
    ds_read_b128 v[36:39], v33 offset:4096
    v_exp_f32 v96, v96
    v_exp_f32 v97, v97
    v_exp_f32 v98, v98
    v_exp_f32 v99, v99
    v_mfma_f32_32x32x8_bf16 v[100:115], v[42:43], v[22:23], v[100:115]
    v_exp_f32 v116, v116
    v_exp_f32 v117, v117
    v_exp_f32 v118, v118
    v_exp_f32 v119, v119
    buffer_load_dword v174, v6, s[56:59], s29 offen
    v_mfma_f32_32x32x8_bf16 v[132:147], v[42:43], v[30:31], v[132:147]
    ds_read_b128 v[40:43], v34 offset:512
    v_exp_f32 v120, v120
    v_exp_f32 v121, v121
    v_exp_f32 v122, v122
    v_exp_f32 v123, v123
    s_waitcnt lgkmcnt(3)
    v_smfmac_f32_32x32x32_bf16 v[52:67], v[44:47], v[84:91], v32
    v_exp_f32 v124, v124
    v_exp_f32 v125, v125
    v_exp_f32 v126, v126
    v_exp_f32 v127, v127
    v_smfmac_f32_32x32x32_bf16 v[68:83], v[44:47], v[116:123], v32
    ds_read_b128 v[44:47], v35 offset:3840
    v_exp_f32 v128, v128
    v_exp_f32 v129, v129
    v_exp_f32 v130, v130
    v_exp_f32 v131, v131
    buffer_load_dword v173, v7, s[52:55], s29 offen
    s_waitcnt lgkmcnt(1)
    v_smfmac_f32_32x32x32_bf16 v[52:67], v[48:51], v[92:99], v32
    v_exp_f32 v100, v100
    v_exp_f32 v101, v101
    v_exp_f32 v102, v102
    v_exp_f32 v103, v103
    v_smfmac_f32_32x32x32_bf16 v[68:83], v[48:51], v[124:131], v32
    ds_read_b128 v[48:51], v35 offset:4480
    v_exp_f32 v104, v104
    v_exp_f32 v105, v105
    v_exp_f32 v106, v106
    v_exp_f32 v107, v107
    v_mfma_f32_32x32x16_bf16 v[84:99], v[36:39], v[16:19], 0
    v_exp_f32 v108, v108
    v_exp_f32 v109, v109
    v_exp_f32 v110, v110
    v_exp_f32 v111, v111
    buffer_load_dword v175, v7, s[56:59], s29 offen
    v_mfma_f32_32x32x16_bf16 v[116:131], v[36:39], v[24:27], 0
    ds_read_b128 v[36:39], v33 offset:5120
    v_exp_f32 v112, v112
    v_exp_f32 v113, v113
    v_exp_f32 v114, v114
    v_exp_f32 v115, v115
    v_mfma_f32_32x32x8_bf16 v[84:99], v[40:41], v[20:21], v[84:99]
    v_exp_f32 v132, v132
    v_exp_f32 v133, v133
    v_exp_f32 v134, v134
    v_exp_f32 v135, v135
    v_mfma_f32_32x32x8_bf16 v[116:131], v[40:41], v[28:29], v[116:131]
    v_exp_f32 v136, v136
    v_exp_f32 v137, v137
    v_exp_f32 v138, v138
    v_exp_f32 v139, v139
    s_add_u32 s29, s29, 73728
    s_waitcnt lgkmcnt(2)
    v_smfmac_f32_32x32x32_bf16 v[52:67], v[44:47], v[100:107], v32
    v_exp_f32 v140, v140
    v_exp_f32 v141, v141
    v_exp_f32 v142, v142
    v_exp_f32 v143, v143
    v_smfmac_f32_32x32x32_bf16 v[68:83], v[44:47], v[132:139], v32
    ds_read_b128 v[44:47], v35 offset:5120
    v_exp_f32 v144, v144
    v_exp_f32 v145, v145
    v_exp_f32 v146, v146
    v_exp_f32 v147, v147
    s_waitcnt lgkmcnt(1)
    v_smfmac_f32_32x32x32_bf16 v[52:67], v[48:51], v[108:115], v32
    v_exp_f32 v84, v84
    v_exp_f32 v85, v85
    v_exp_f32 v86, v86
    v_exp_f32 v87, v87
    buffer_load_dword v176, v6, s[52:55], s29 offen
    v_smfmac_f32_32x32x32_bf16 v[68:83], v[48:51], v[140:147], v32
    ds_read_b128 v[48:51], v35 offset:5760
    v_exp_f32 v88, v88
    v_exp_f32 v89, v89
    v_exp_f32 v90, v90
    v_exp_f32 v91, v91
    v_mfma_f32_32x32x16_bf16 v[100:115], v[36:39], v[16:19], 0
    v_exp_f32 v92, v92
    v_exp_f32 v93, v93
    v_exp_f32 v94, v94
    v_exp_f32 v95, v95
    v_mfma_f32_32x32x16_bf16 v[132:147], v[36:39], v[24:27], 0
    ds_read_b128 v[36:39], v33 offset:6144
    v_exp_f32 v96, v96
    v_exp_f32 v97, v97
    v_exp_f32 v98, v98
    v_exp_f32 v99, v99
    buffer_load_dword v178, v6, s[56:59], s29 offen
    v_mfma_f32_32x32x8_bf16 v[100:115], v[40:41], v[22:23], v[100:115]
    v_exp_f32 v116, v116
    v_exp_f32 v117, v117
    v_exp_f32 v118, v118
    v_exp_f32 v119, v119
    v_mfma_f32_32x32x8_bf16 v[132:147], v[40:41], v[30:31], v[132:147]
    v_exp_f32 v120, v120
    v_exp_f32 v121, v121
    v_exp_f32 v122, v122
    v_exp_f32 v123, v123
    s_waitcnt lgkmcnt(2)
    v_smfmac_f32_32x32x32_bf16 v[52:67], v[44:47], v[84:91], v32
    v_exp_f32 v124, v124
    v_exp_f32 v125, v125
    v_exp_f32 v126, v126
    v_exp_f32 v127, v127
    buffer_load_dword v177, v7, s[52:55], s29 offen
    v_smfmac_f32_32x32x32_bf16 v[68:83], v[44:47], v[116:123], v32
    ds_read_b128 v[44:47], v35 offset:6400
    v_exp_f32 v128, v128
    v_exp_f32 v129, v129
    v_exp_f32 v130, v130
    v_exp_f32 v131, v131
    s_waitcnt lgkmcnt(1)
    v_smfmac_f32_32x32x32_bf16 v[52:67], v[48:51], v[92:99], v32
    v_exp_f32 v100, v100
    v_exp_f32 v101, v101
    v_exp_f32 v102, v102
    v_exp_f32 v103, v103
    v_smfmac_f32_32x32x32_bf16 v[68:83], v[48:51], v[124:131], v32
    ds_read_b128 v[48:51], v35 offset:7040
    v_exp_f32 v104, v104
    v_exp_f32 v105, v105
    v_exp_f32 v106, v106
    v_exp_f32 v107, v107
    buffer_load_dword v179, v7, s[56:59], s29 offen
    v_mfma_f32_32x32x16_bf16 v[84:99], v[36:39], v[16:19], 0
    v_exp_f32 v108, v108
    v_exp_f32 v109, v109
    v_exp_f32 v110, v110
    v_exp_f32 v111, v111
    v_mfma_f32_32x32x16_bf16 v[116:131], v[36:39], v[24:27], 0
    ds_read_b128 v[36:39], v33 offset:7168
    v_exp_f32 v112, v112
    v_exp_f32 v113, v113
    v_exp_f32 v114, v114
    v_exp_f32 v115, v115
    v_mfma_f32_32x32x8_bf16 v[84:99], v[42:43], v[20:21], v[84:99]
    v_exp_f32 v132, v132
    v_exp_f32 v133, v133
    v_exp_f32 v134, v134
    v_exp_f32 v135, v135
    s_add_u32 s29, s29, 73728
    v_mfma_f32_32x32x8_bf16 v[116:131], v[42:43], v[28:29], v[116:131]
    v_exp_f32 v136, v136
    v_exp_f32 v137, v137
    v_exp_f32 v138, v138
    v_exp_f32 v139, v139
    s_waitcnt lgkmcnt(2)
    v_smfmac_f32_32x32x32_bf16 v[52:67], v[44:47], v[100:107], v32
    v_exp_f32 v140, v140
    v_exp_f32 v141, v141
    v_exp_f32 v142, v142
    v_exp_f32 v143, v143
    v_smfmac_f32_32x32x32_bf16 v[68:83], v[44:47], v[132:139], v32
    ds_read_b128 v[44:47], v35 offset:7680
    v_exp_f32 v144, v144
    v_exp_f32 v145, v145
    v_exp_f32 v146, v146
    v_exp_f32 v147, v147
    buffer_load_dword v180, v6, s[52:55], s29 offen
    s_waitcnt lgkmcnt(1)
    v_smfmac_f32_32x32x32_bf16 v[52:67], v[48:51], v[108:115], v32
    v_exp_f32 v84, v84
    v_exp_f32 v85, v85
    v_exp_f32 v86, v86
    v_exp_f32 v87, v87
    v_smfmac_f32_32x32x32_bf16 v[68:83], v[48:51], v[140:147], v32
    ds_read_b128 v[48:51], v35 offset:8320
    v_exp_f32 v88, v88
    v_exp_f32 v89, v89
    v_exp_f32 v90, v90
    v_exp_f32 v91, v91
    v_mfma_f32_32x32x16_bf16 v[100:115], v[36:39], v[16:19], 0
    v_exp_f32 v92, v92
    v_exp_f32 v93, v93
    v_exp_f32 v94, v94
    v_exp_f32 v95, v95
    buffer_load_dword v182, v6, s[56:59], s29 offen
    v_mfma_f32_32x32x16_bf16 v[132:147], v[36:39], v[24:27], 0
    ds_read_b128 v[36:39], v33 offset:8192
    v_exp_f32 v96, v96
    v_exp_f32 v97, v97
    v_exp_f32 v98, v98
    v_exp_f32 v99, v99
    v_mfma_f32_32x32x8_bf16 v[100:115], v[42:43], v[22:23], v[100:115]
    v_exp_f32 v116, v116
    v_exp_f32 v117, v117
    v_exp_f32 v118, v118
    v_exp_f32 v119, v119
    v_mfma_f32_32x32x8_bf16 v[132:147], v[42:43], v[30:31], v[132:147]
    ds_read_b128 v[40:43], v34 offset:1024
    v_exp_f32 v120, v120
    v_exp_f32 v121, v121
    v_exp_f32 v122, v122
    v_exp_f32 v123, v123
    buffer_load_dword v181, v7, s[52:55], s29 offen
    s_waitcnt lgkmcnt(3)
    v_smfmac_f32_32x32x32_bf16 v[52:67], v[44:47], v[84:91], v32
    v_exp_f32 v124, v124
    v_exp_f32 v125, v125
    v_exp_f32 v126, v126
    v_exp_f32 v127, v127
    v_smfmac_f32_32x32x32_bf16 v[68:83], v[44:47], v[116:123], v32
    ds_read_b128 v[44:47], v35 offset:8960
    v_exp_f32 v128, v128
    v_exp_f32 v129, v129
    v_exp_f32 v130, v130
    v_exp_f32 v131, v131
    s_waitcnt lgkmcnt(1)
    v_smfmac_f32_32x32x32_bf16 v[52:67], v[48:51], v[92:99], v32
    v_exp_f32 v100, v100
    v_exp_f32 v101, v101
    v_exp_f32 v102, v102
    v_exp_f32 v103, v103
    buffer_load_dword v183, v7, s[56:59], s29 offen
    v_smfmac_f32_32x32x32_bf16 v[68:83], v[48:51], v[124:131], v32
    ds_read_b128 v[48:51], v35 offset:9600
    v_exp_f32 v104, v104
    v_exp_f32 v105, v105
    v_exp_f32 v106, v106
    v_exp_f32 v107, v107
    v_mfma_f32_32x32x16_bf16 v[84:99], v[36:39], v[16:19], 0
    v_exp_f32 v108, v108
    v_exp_f32 v109, v109
    v_exp_f32 v110, v110
    v_exp_f32 v111, v111
    v_mfma_f32_32x32x16_bf16 v[116:131], v[36:39], v[24:27], 0
    ds_read_b128 v[36:39], v33 offset:9216
    v_exp_f32 v112, v112
    v_exp_f32 v113, v113
    v_exp_f32 v114, v114
    v_exp_f32 v115, v115
    v_mfma_f32_32x32x8_bf16 v[84:99], v[40:41], v[20:21], v[84:99]
    v_exp_f32 v132, v132
    v_exp_f32 v133, v133
    v_exp_f32 v134, v134
    v_exp_f32 v135, v135
    v_mfma_f32_32x32x8_bf16 v[116:131], v[40:41], v[28:29], v[116:131]
    v_exp_f32 v136, v136
    v_exp_f32 v137, v137
    v_exp_f32 v138, v138
    v_exp_f32 v139, v139
    s_waitcnt lgkmcnt(2)
    v_smfmac_f32_32x32x32_bf16 v[52:67], v[44:47], v[100:107], v32
    v_exp_f32 v140, v140
    v_exp_f32 v141, v141
    v_exp_f32 v142, v142
    v_exp_f32 v143, v143
    v_smfmac_f32_32x32x32_bf16 v[68:83], v[44:47], v[132:139], v32
    ds_read_b128 v[44:47], v35 offset:10240
    v_exp_f32 v144, v144
    v_exp_f32 v145, v145
    v_exp_f32 v146, v146
    v_exp_f32 v147, v147
    v_add_u32 v33, 8192, v33
    v_add_u32 v34, 1024, v34
    v_add_u32 v35, 10240, v35
    s_waitcnt lgkmcnt(1)
    s_waitcnt vmcnt(0)
    s_mov_b32 s28, 18432
    v_lshlrev_b32 v8, 2, v2
    v_mul_u32_u24 v9, 4608, v3
    s_mul_i32 s90, s89, 27648
    v_mul_u32_u24 v10, 2304, v3
    v_add_u32 v9, v9, v8
    v_add3_u32 v8, v8, v10, s28
    s_lshl_b32 s30, s84, 6
    s_add_u32 s30, s30, s90
    s_add_u32 s31, s84, 16
    s_min_u32 s31, s31, 17
    s_lshl_b32 s31, s31, 6
    s_add_u32 s31, s31, s90
    v_cmp_gt_u32 vcc, 4, v2
    v_cmp_gt_u32 s[68:69], 3, v3
    s_nop 0
    s_and_b64 s[68:69], s[68:69], vcc
    s_cmp_eq_u32 s48, 0
    s_cbranch_scc1 L_p0_52
    s_setprio 1
    s_branch L_p1_53
L_p0_52:
    s_setprio 0
L_p1_53:
    s_nop 3
    v_smfmac_f32_32x32x32_bf16 v[52:67], v[48:51], v[108:115], v32
    v_exp_f32 v84, v84
    v_exp_f32 v85, v85
    buffer_load_dword v194, v9, s[60:63], s30 offen offset:0
    v_exp_f32 v86, v86
    v_exp_f32 v87, v87
    v_smfmac_f32_32x32x32_bf16 v[68:83], v[48:51], v[140:147], v32
    ds_read_b128 v[48:51], v35 offset:640
    v_exp_f32 v88, v88
    v_exp_f32 v89, v89
    v_exp_f32 v90, v90
    v_exp_f32 v91, v91
    v_mfma_f32_32x32x16_bf16 v[100:115], v[36:39], v[16:19], 0
    v_exp_f32 v92, v92
    v_exp_f32 v93, v93
    buffer_load_dword v195, v9, s[60:63], s30 offen offset:1152
    v_perm_b32 v220, v184, v184, v250
    v_perm_b32 v221, v184, v184, v251
    v_exp_f32 v94, v94
    v_exp_f32 v95, v95
    v_mfma_f32_32x32x16_bf16 v[132:147], v[36:39], v[24:27], 0
    ds_read_b128 v[36:39], v33 offset:2048
    v_exp_f32 v96, v96
    v_exp_f32 v97, v97
    v_exp_f32 v98, v98
    v_exp_f32 v99, v99
    v_perm_b32 v222, v185, v185, v250
    v_perm_b32 v223, v185, v185, v251
    v_mfma_f32_32x32x8_bf16 v[100:115], v[40:41], v[22:23], v[100:115]
    v_exp_f32 v116, v116
    v_exp_f32 v117, v117
    buffer_load_dword v196, v9, s[60:63], s30 offen offset:2304
    v_exp_f32 v118, v118
    v_exp_f32 v119, v119
    v_mfma_f32_32x32x8_bf16 v[132:147], v[40:41], v[30:31], v[132:147]
    v_exp_f32 v120, v120
    v_exp_f32 v121, v121
    v_mfma_f32_16x16x16_bf16 v[212:215], v[148:149], v[220:221], 0
    v_exp_f32 v122, v122
    v_exp_f32 v123, v123
    s_waitcnt lgkmcnt(2)
    v_smfmac_f32_32x32x32_bf16 v[52:67], v[44:47], v[84:91], v32
    v_exp_f32 v124, v124
    v_exp_f32 v125, v125
    buffer_load_dword v197, v9, s[60:63], s30 offen offset:3456
    v_exp_f32 v126, v126
    v_exp_f32 v127, v127
    v_mfma_f32_16x16x16_bf16 v[216:219], v[150:151], v[220:221], 0
    v_smfmac_f32_32x32x32_bf16 v[68:83], v[44:47], v[116:123], v32
    ds_read_b128 v[44:47], v35 offset:1280
    v_exp_f32 v128, v128
    v_exp_f32 v129, v129
    v_exp_f32 v130, v130
    v_exp_f32 v131, v131
    s_waitcnt lgkmcnt(1)
    v_smfmac_f32_32x32x32_bf16 v[52:67], v[48:51], v[92:99], v32
    v_exp_f32 v100, v100
    v_exp_f32 v101, v101
    v_exp_f32 v102, v102
    v_exp_f32 v103, v103
    buffer_load_dword v198, v8, s[60:63], s30 offen offset:0
    v_perm_b32 v224, v186, v186, v250
    v_perm_b32 v225, v186, v186, v251
    v_smfmac_f32_32x32x32_bf16 v[68:83], v[48:51], v[124:131], v32
    ds_read_b128 v[48:51], v35 offset:1920
    v_exp_f32 v104, v104
    v_exp_f32 v105, v105
    v_exp_f32 v106, v106
    v_exp_f32 v107, v107
    v_mfma_f32_32x32x16_bf16 v[84:99], v[36:39], v[16:19], 0
    v_exp_f32 v108, v108
    v_exp_f32 v109, v109
    v_mfma_f32_16x16x16_bf16 v[212:215], v[152:153], v[222:223], v[212:215]
    v_exp_f32 v110, v110
    v_exp_f32 v111, v111
    buffer_load_dword v199, v8, s[60:63], s30 offen offset:1152
    v_mfma_f32_32x32x16_bf16 v[116:131], v[36:39], v[24:27], 0
    ds_read_b128 v[36:39], v33 offset:3072
    v_exp_f32 v112, v112
    v_exp_f32 v113, v113
    v_exp_f32 v114, v114
    v_exp_f32 v115, v115
    v_mfma_f32_16x16x16_bf16 v[216:219], v[154:155], v[222:223], v[216:219]
    v_mfma_f32_32x32x8_bf16 v[84:99], v[42:43], v[20:21], v[84:99]
    v_exp_f32 v132, v132
    v_exp_f32 v133, v133
    v_exp_f32 v134, v134
    v_exp_f32 v135, v135
    s_add_u32 s30, s30, 512
    v_mfma_f32_32x32x8_bf16 v[116:131], v[42:43], v[28:29], v[116:131]
    v_exp_f32 v136, v136
    v_exp_f32 v137, v137
    v_exp_f32 v138, v138
    v_exp_f32 v139, v139
    v_perm_b32 v226, v187, v187, v250
    v_perm_b32 v227, v187, v187, v251
    s_waitcnt lgkmcnt(2)
    v_smfmac_f32_32x32x32_bf16 v[52:67], v[44:47], v[100:107], v32
    v_exp_f32 v140, v140
    v_exp_f32 v141, v141
    v_exp_f32 v142, v142
    v_exp_f32 v143, v143
    buffer_load_dword v200, v9, s[60:63], s30 offen offset:0
    v_smfmac_f32_32x32x32_bf16 v[68:83], v[44:47], v[132:139], v32
    ds_read_b128 v[44:47], v35 offset:2560
    v_exp_f32 v144, v144
    v_exp_f32 v145, v145
    v_mfma_f32_16x16x16_bf16 v[212:215], v[156:157], v[224:225], v[212:215]
    v_exp_f32 v146, v146
    v_exp_f32 v147, v147
    s_waitcnt lgkmcnt(1)
    v_smfmac_f32_32x32x32_bf16 v[52:67], v[48:51], v[108:115], v32
    v_exp_f32 v84, v84
    v_exp_f32 v85, v85
    v_exp_f32 v86, v86
    v_exp_f32 v87, v87
    v_mfma_f32_16x16x16_bf16 v[216:219], v[158:159], v[224:225], v[216:219]
    v_smfmac_f32_32x32x32_bf16 v[68:83], v[48:51], v[140:147], v32
    ds_read_b128 v[48:51], v35 offset:3200
    v_exp_f32 v88, v88
    v_exp_f32 v89, v89
    buffer_load_dword v201, v9, s[60:63], s30 offen offset:1152
    v_exp_f32 v90, v90
    v_exp_f32 v91, v91
    v_mfma_f32_32x32x16_bf16 v[100:115], v[36:39], v[16:19], 0
    v_exp_f32 v92, v92
    v_exp_f32 v93, v93
    v_perm_b32 v228, v188, v188, v250
    v_perm_b32 v229, v188, v188, v251
    v_exp_f32 v94, v94
    v_exp_f32 v95, v95
    v_mfma_f32_32x32x16_bf16 v[132:147], v[36:39], v[24:27], 0
    ds_read_b128 v[36:39], v33 offset:4096
    v_exp_f32 v96, v96
    v_exp_f32 v97, v97
    buffer_load_dword v202, v9, s[60:63], s30 offen offset:2304
    v_exp_f32 v98, v98
    v_exp_f32 v99, v99
    v_mfma_f32_32x32x8_bf16 v[100:115], v[42:43], v[22:23], v[100:115]
    v_exp_f32 v116, v116
    v_exp_f32 v117, v117
    v_mfma_f32_16x16x16_bf16 v[212:215], v[160:161], v[226:227], v[212:215]
    v_exp_f32 v118, v118
    v_exp_f32 v119, v119
    v_mfma_f32_32x32x8_bf16 v[132:147], v[42:43], v[30:31], v[132:147]
    ds_read_b128 v[40:43], v34 offset:512
    v_exp_f32 v120, v120
    v_exp_f32 v121, v121
    buffer_load_dword v203, v9, s[60:63], s30 offen offset:3456
    v_exp_f32 v122, v122
    v_exp_f32 v123, v123
    v_mfma_f32_16x16x16_bf16 v[216:219], v[162:163], v[226:227], v[216:219]
    s_waitcnt lgkmcnt(3)
    v_smfmac_f32_32x32x32_bf16 v[52:67], v[44:47], v[84:91], v32
    v_exp_f32 v124, v124
    v_exp_f32 v125, v125
    v_exp_f32 v126, v126
    v_exp_f32 v127, v127
    v_smfmac_f32_32x32x32_bf16 v[68:83], v[44:47], v[116:123], v32
    ds_read_b128 v[44:47], v35 offset:3840
    v_exp_f32 v128, v128
    v_exp_f32 v129, v129
    buffer_load_dword v204, v8, s[60:63], s30 offen offset:0
    v_perm_b32 v230, v189, v189, v250
    v_perm_b32 v231, v189, v189, v251
    v_exp_f32 v130, v130
    v_exp_f32 v131, v131
    s_waitcnt lgkmcnt(1)
    v_smfmac_f32_32x32x32_bf16 v[52:67], v[48:51], v[92:99], v32
    v_exp_f32 v100, v100
    v_exp_f32 v101, v101
    v_exp_f32 v102, v102
    v_exp_f32 v103, v103
    v_smfmac_f32_32x32x32_bf16 v[68:83], v[48:51], v[124:131], v32
    ds_read_b128 v[48:51], v35 offset:4480
    v_exp_f32 v104, v104
    v_exp_f32 v105, v105
    v_mfma_f32_16x16x16_bf16 v[212:215], v[164:165], v[228:229], v[212:215]
    v_exp_f32 v106, v106
    v_exp_f32 v107, v107
    buffer_load_dword v205, v8, s[60:63], s30 offen offset:1152
    v_mfma_f32_32x32x16_bf16 v[84:99], v[36:39], v[16:19], 0
    v_exp_f32 v108, v108
    v_exp_f32 v109, v109
    v_exp_f32 v110, v110
    v_exp_f32 v111, v111
    v_mfma_f32_16x16x16_bf16 v[216:219], v[166:167], v[228:229], v[216:219]
    v_mfma_f32_32x32x16_bf16 v[116:131], v[36:39], v[24:27], 0
    ds_read_b128 v[36:39], v33 offset:5120
    v_exp_f32 v112, v112
    v_exp_f32 v113, v113
    v_exp_f32 v114, v114
    v_exp_f32 v115, v115
    buffer_load_dword v206, v9, s[60:63], s31 offen offset:0
    v_mfma_f32_32x32x8_bf16 v[84:99], v[40:41], v[20:21], v[84:99]
    v_exp_f32 v132, v132
    v_exp_f32 v133, v133
    v_perm_b32 v232, v190, v190, v250
    v_perm_b32 v233, v190, v190, v251
    v_exp_f32 v134, v134
    v_exp_f32 v135, v135
    v_mfma_f32_32x32x8_bf16 v[116:131], v[40:41], v[28:29], v[116:131]
    v_exp_f32 v136, v136
    v_exp_f32 v137, v137
    v_exp_f32 v138, v138
    v_exp_f32 v139, v139
    buffer_load_dword v207, v9, s[60:63], s31 offen offset:1152
    s_waitcnt lgkmcnt(2)
    v_smfmac_f32_32x32x32_bf16 v[52:67], v[44:47], v[100:107], v32
    v_exp_f32 v140, v140
    v_exp_f32 v141, v141
    v_mfma_f32_16x16x16_bf16 v[212:215], v[168:169], v[230:231], v[212:215]
    v_exp_f32 v142, v142
    v_exp_f32 v143, v143
    v_smfmac_f32_32x32x32_bf16 v[68:83], v[44:47], v[132:139], v32
    ds_read_b128 v[44:47], v35 offset:5120
    v_exp_f32 v144, v144
    v_exp_f32 v145, v145
    v_exp_f32 v146, v146
    v_exp_f32 v147, v147
    buffer_load_dword v208, v9, s[60:63], s31 offen offset:2304
    v_mfma_f32_16x16x16_bf16 v[216:219], v[170:171], v[230:231], v[216:219]
    s_waitcnt lgkmcnt(1)
    v_smfmac_f32_32x32x32_bf16 v[52:67], v[48:51], v[108:115], v32
    v_exp_f32 v84, v84
    v_exp_f32 v85, v85
    v_exp_f32 v86, v86
    v_exp_f32 v87, v87
    v_smfmac_f32_32x32x32_bf16 v[68:83], v[48:51], v[140:147], v32
    ds_read_b128 v[48:51], v35 offset:5760
    v_exp_f32 v88, v88
    v_exp_f32 v89, v89
    v_perm_b32 v234, v191, v191, v250
    v_perm_b32 v235, v191, v191, v251
    v_exp_f32 v90, v90
    v_exp_f32 v91, v91
    v_mfma_f32_32x32x16_bf16 v[100:115], v[36:39], v[16:19], 0
    v_exp_f32 v92, v92
    v_exp_f32 v93, v93
    buffer_load_dword v209, v9, s[60:63], s31 offen offset:3456
    v_exp_f32 v94, v94
    v_exp_f32 v95, v95
    v_mfma_f32_16x16x16_bf16 v[212:215], v[172:173], v[232:233], v[212:215]
    v_mfma_f32_32x32x16_bf16 v[132:147], v[36:39], v[24:27], 0
    ds_read_b128 v[36:39], v33 offset:6144
    v_exp_f32 v96, v96
    v_exp_f32 v97, v97
    v_exp_f32 v98, v98
    v_exp_f32 v99, v99
    v_mfma_f32_32x32x8_bf16 v[100:115], v[40:41], v[22:23], v[100:115]
    v_exp_f32 v116, v116
    v_exp_f32 v117, v117
    buffer_load_dword v210, v8, s[60:63], s31 offen offset:0
    v_exp_f32 v118, v118
    v_exp_f32 v119, v119
    v_mfma_f32_16x16x16_bf16 v[216:219], v[174:175], v[232:233], v[216:219]
    v_mfma_f32_32x32x8_bf16 v[132:147], v[40:41], v[30:31], v[132:147]
    v_exp_f32 v120, v120
    v_exp_f32 v121, v121
    v_exp_f32 v122, v122
    v_exp_f32 v123, v123
    s_waitcnt lgkmcnt(2)
    v_smfmac_f32_32x32x32_bf16 v[52:67], v[44:47], v[84:91], v32
    v_exp_f32 v124, v124
    v_exp_f32 v125, v125
    buffer_load_dword v211, v8, s[60:63], s31 offen offset:1152
    v_perm_b32 v236, v192, v192, v250
    v_perm_b32 v237, v192, v192, v251
    v_exp_f32 v126, v126
    v_exp_f32 v127, v127
    v_smfmac_f32_32x32x32_bf16 v[68:83], v[44:47], v[116:123], v32
    ds_read_b128 v[44:47], v35 offset:6400
    v_exp_f32 v128, v128
    v_exp_f32 v129, v129
    v_exp_f32 v130, v130
    v_exp_f32 v131, v131
    v_mfma_f32_16x16x16_bf16 v[212:215], v[176:177], v[234:235], v[212:215]
    s_waitcnt lgkmcnt(1)
    v_smfmac_f32_32x32x32_bf16 v[52:67], v[48:51], v[92:99], v32
    v_exp_f32 v100, v100
    v_exp_f32 v101, v101
    v_exp_f32 v102, v102
    v_exp_f32 v103, v103
    v_smfmac_f32_32x32x32_bf16 v[68:83], v[48:51], v[124:131], v32
    ds_read_b128 v[48:51], v35 offset:7040
    v_exp_f32 v104, v104
    v_exp_f32 v105, v105
    v_exp_f32 v106, v106
    v_exp_f32 v107, v107
    v_mfma_f32_16x16x16_bf16 v[216:219], v[178:179], v[234:235], v[216:219]
    v_mfma_f32_32x32x16_bf16 v[84:99], v[36:39], v[16:19], 0
    v_exp_f32 v108, v108
    v_exp_f32 v109, v109
    v_exp_f32 v110, v110
    v_exp_f32 v111, v111
    v_mfma_f32_32x32x16_bf16 v[116:131], v[36:39], v[24:27], 0
    ds_read_b128 v[36:39], v33 offset:7168
    v_exp_f32 v112, v112
    v_exp_f32 v113, v113
    v_mfma_f32_16x16x16_bf16 v[212:215], v[180:181], v[236:237], v[212:215]
    v_exp_f32 v114, v114
    v_exp_f32 v115, v115
    v_mfma_f32_32x32x8_bf16 v[84:99], v[42:43], v[20:21], v[84:99]
    v_exp_f32 v132, v132
    v_exp_f32 v133, v133
    v_exp_f32 v134, v134
    v_exp_f32 v135, v135
    v_mfma_f32_16x16x16_bf16 v[216:219], v[182:183], v[236:237], v[216:219]
    v_mfma_f32_32x32x8_bf16 v[116:131], v[42:43], v[28:29], v[116:131]
    v_exp_f32 v136, v136
    v_exp_f32 v137, v137
    v_exp_f32 v138, v138
    v_exp_f32 v139, v139
    s_waitcnt lgkmcnt(2)
    v_smfmac_f32_32x32x32_bf16 v[52:67], v[44:47], v[100:107], v32
    v_exp_f32 v140, v140
    v_exp_f32 v141, v141
    v_exp_f32 v142, v142
    v_exp_f32 v143, v143
    v_smfmac_f32_32x32x32_bf16 v[68:83], v[44:47], v[132:139], v32
    ds_read_b128 v[44:47], v35 offset:7680
    v_exp_f32 v144, v144
    v_exp_f32 v145, v145
    v_exp_f32 v146, v146
    v_exp_f32 v147, v147
    s_waitcnt lgkmcnt(1)
    v_smfmac_f32_32x32x32_bf16 v[52:67], v[48:51], v[108:115], v32
    v_exp_f32 v84, v84
    v_exp_f32 v85, v85
    v_exp_f32 v86, v86
    v_exp_f32 v87, v87
    v_smfmac_f32_32x32x32_bf16 v[68:83], v[48:51], v[140:147], v32
    ds_read_b128 v[48:51], v35 offset:8320
    v_exp_f32 v88, v88
    v_exp_f32 v89, v89
    v_exp_f32 v90, v90
    v_exp_f32 v91, v91
    v_mfma_f32_32x32x16_bf16 v[100:115], v[36:39], v[16:19], 0
    v_exp_f32 v92, v92
    v_exp_f32 v93, v93
    v_exp_f32 v94, v94
    v_exp_f32 v95, v95
    v_mfma_f32_32x32x16_bf16 v[132:147], v[36:39], v[24:27], 0
    ds_read_b128 v[36:39], v33 offset:8192
    v_exp_f32 v96, v96
    v_exp_f32 v97, v97
    v_exp_f32 v98, v98
    v_exp_f32 v99, v99
    v_mfma_f32_32x32x8_bf16 v[100:115], v[42:43], v[22:23], v[100:115]
    v_exp_f32 v116, v116
    v_exp_f32 v117, v117
    s_mov_b64 exec, s[68:69]
    ds_write_b32 v252, v212 offset:0
    ds_write_b32 v252, v213 offset:128
    ds_write_b32 v252, v214 offset:256
    ds_write_b32 v252, v215 offset:384
    s_mov_b64 exec, -1
    v_exp_f32 v118, v118
    v_exp_f32 v119, v119
    v_mfma_f32_32x32x8_bf16 v[132:147], v[42:43], v[30:31], v[132:147]
    ds_read_b128 v[40:43], v34 offset:1024
    v_exp_f32 v120, v120
    v_exp_f32 v121, v121
    v_exp_f32 v122, v122
    v_exp_f32 v123, v123
    s_waitcnt lgkmcnt(7)
    v_smfmac_f32_32x32x32_bf16 v[52:67], v[44:47], v[84:91], v32
    v_exp_f32 v124, v124
    v_exp_f32 v125, v125
    s_mov_b64 exec, s[68:69]
    ds_write_b32 v252, v216 offset:1536
    ds_write_b32 v252, v217 offset:1664
    ds_write_b32 v252, v218 offset:1792
    ds_write_b32 v252, v219 offset:1920
    s_mov_b64 exec, -1
    v_exp_f32 v126, v126
    v_exp_f32 v127, v127
    v_smfmac_f32_32x32x32_bf16 v[68:83], v[44:47], v[116:123], v32
    ds_read_b128 v[44:47], v35 offset:8960
    v_exp_f32 v128, v128
    v_exp_f32 v129, v129
    v_exp_f32 v130, v130
    v_exp_f32 v131, v131
    s_waitcnt lgkmcnt(5)
    v_smfmac_f32_32x32x32_bf16 v[52:67], v[48:51], v[92:99], v32
    v_exp_f32 v100, v100
    v_exp_f32 v101, v101
    v_exp_f32 v102, v102
    v_exp_f32 v103, v103
    v_smfmac_f32_32x32x32_bf16 v[68:83], v[48:51], v[124:131], v32
    ds_read_b128 v[48:51], v35 offset:9600
    v_exp_f32 v104, v104
    v_exp_f32 v105, v105
    v_exp_f32 v106, v106
    v_exp_f32 v107, v107
    v_mfma_f32_32x32x16_bf16 v[84:99], v[36:39], v[16:19], 0
    v_exp_f32 v108, v108
    v_exp_f32 v109, v109
    v_exp_f32 v110, v110
    v_exp_f32 v111, v111
    v_mfma_f32_32x32x16_bf16 v[116:131], v[36:39], v[24:27], 0
    ds_read_b128 v[36:39], v33 offset:9216
    v_exp_f32 v112, v112
    v_exp_f32 v113, v113
    v_exp_f32 v114, v114
    v_exp_f32 v115, v115
    v_mfma_f32_32x32x8_bf16 v[84:99], v[40:41], v[20:21], v[84:99]
    v_exp_f32 v132, v132
    v_exp_f32 v133, v133
    v_exp_f32 v134, v134
    v_exp_f32 v135, v135
    v_mfma_f32_32x32x8_bf16 v[116:131], v[40:41], v[28:29], v[116:131]
    v_exp_f32 v136, v136
    v_exp_f32 v137, v137
    v_exp_f32 v138, v138
    v_exp_f32 v139, v139
    s_waitcnt lgkmcnt(2)
    v_smfmac_f32_32x32x32_bf16 v[52:67], v[44:47], v[100:107], v32
    v_exp_f32 v140, v140
    v_exp_f32 v141, v141
    v_exp_f32 v142, v142
    v_exp_f32 v143, v143
    v_smfmac_f32_32x32x32_bf16 v[68:83], v[44:47], v[132:139], v32
    ds_read_b128 v[44:47], v35 offset:10240
    v_exp_f32 v144, v144
    v_exp_f32 v145, v145
    v_exp_f32 v146, v146
    v_exp_f32 v147, v147
    v_add_u32 v33, 8192, v33
    v_add_u32 v34, 1024, v34
    v_add_u32 v35, 10240, v35
    s_waitcnt lgkmcnt(1)
    s_waitcnt vmcnt(0) lgkmcnt(0)
    s_barrier
    s_and_b32 s90, s84, 1
    s_mul_i32 s90, s90, 18
    s_bfe_u32 s91, s84, 0x10001
    s_lshl2_add_u32 s90, s91, s90
    s_mul_i32 s91, s48, 36
    s_add_u32 s90, s90, s91
    s_mul_i32 s64, s90, 1152
    s_mul_i32 s95, s86, 72
    s_add_u32 s64, s64, s95
    s_mul_i32 s65, s84, 82944
    s_add_u32 s65, s65, s95
    s_add_u32 s65, s65, 18432
    s_mul_i32 s66, s48, 13312
    s_sub_u32 s67, 19456, s66
    s_add_u32 s66, s66, 6144
    s_mul_i32 s91, s84, 768
    s_add_u32 m0, s91, 73728
    s_getpc_b64 s[30:31]
L_pc_54:
    s_add_u32 s30, s30, L_tail_start-L_pc_54
    s_addc_u32 s31, s31, 0
    v_and_b32 v15, 7, v1
    v_lshl_add_u32 v15, s84, 3, v15
    v_lshlrev_b32 v15, 7, v15
    v_min_u32 v15, L_code_end-L_tail_start-4, v15
    s_and_b32 s29, s2, 3
    s_mul_i32 s29, s29, 4608
    s_add_u32 s29, s29, 159744
    v_mov_b32 v160, 156680
    v_mov_b32 v161, 1
    v_mov_b32 v162, s88
    v_mov_b32 v163, 0
    s_lshl_b32 s70, s2, 7
    s_add_u32 s70, s70, 204800
    s_cmp_eq_u32 s48, 1
    s_cbranch_scc1 L_p0_56
    s_setprio 1
    s_branch L_p1_57
L_p0_56:
    s_setprio 0
L_p1_57:
    s_nop 3
    v_smfmac_f32_32x32x32_bf16 v[52:67], v[48:51], v[108:115], v32
    v_exp_f32 v84, v84
    v_exp_f32 v85, v85
    s_mov_b32 exec_hi, 0xffff
    buffer_load_dwordx4 v244, s[44:47], s64 offen lds
    s_mov_b32 exec_hi, -1
    v_lshlrev_b32 v12, 5, v1
    v_add_u32 v12, 157952, v12
    v_exp_f32 v86, v86
    v_exp_f32 v87, v87
    ds_read_b128 v[220:223], v12
    ds_read_b128 v[224:227], v12 offset:16
    v_smfmac_f32_32x32x32_bf16 v[68:83], v[48:51], v[140:147], v32
    ds_read_b128 v[48:51], v35 offset:640
    v_exp_f32 v88, v88
    v_exp_f32 v89, v89
    ds_read_b128 v[228:231], v12 offset:1536
    ds_read_b128 v[232:235], v12 offset:1552
    v_exp_f32 v90, v90
    v_exp_f32 v91, v91
    v_mfma_f32_32x32x16_bf16 v[100:115], v[36:39], v[16:19], 0
    v_exp_f32 v92, v92
    v_exp_f32 v93, v93
    s_add_u32 m0, m0, 6144
    s_waitcnt lgkmcnt(0)
    v_pk_add_f32 v[220:221], v[220:221], v[224:225]
    v_pk_add_f32 v[222:223], v[222:223], v[226:227]
    v_pk_add_f32 v[228:229], v[228:229], v[232:233]
    v_pk_add_f32 v[230:231], v[230:231], v[234:235]
    v_exp_f32 v94, v94
    v_exp_f32 v95, v95
    v_pk_add_f32 v[220:221], v[220:221], v[222:223]
    v_pk_add_f32 v[228:229], v[228:229], v[230:231]
    v_mfma_f32_32x32x16_bf16 v[132:147], v[36:39], v[24:27], 0
    ds_read_b128 v[36:39], v33 offset:2048
    v_exp_f32 v96, v96
    v_exp_f32 v97, v97
    v_add_f32 v10, v220, v221
    v_add_f32 v11, v228, v229
    v_exp_f32 v98, v98
    v_exp_f32 v99, v99
    v_cvt_pk_bf16_f32 v10, v10, v10
    v_cvt_pk_bf16_f32 v11, v11, v11
    v_mfma_f32_32x32x8_bf16 v[100:115], v[40:41], v[22:23], v[100:115]
    v_exp_f32 v116, v116
    v_exp_f32 v117, v117
    v_exp_f32 v118, v118
    v_exp_f32 v119, v119
    s_add_u32 s64, s64, 82944
    v_lshlrev_b32 v10, 16, v10
    v_lshlrev_b32 v11, 16, v11
    v_mul_f32 v13, 0xbfb8aa3b, v10
    v_mfma_f32_32x32x8_bf16 v[132:147], v[40:41], v[30:31], v[132:147]
    v_exp_f32 v120, v120
    v_exp_f32 v121, v121
    v_exp_f32 v13, v13
    v_exp_f32 v122, v122
    v_exp_f32 v123, v123
    v_add_f32 v13, 1.0, v13
    v_smfmac_f32_32x32x32_bf16 v[52:67], v[44:47], v[84:91], v32
    v_exp_f32 v124, v124
    v_exp_f32 v125, v125
    v_rcp_f32 v13, v13
    v_exp_f32 v126, v126
    v_exp_f32 v127, v127
    s_mov_b32 exec_hi, 0xffff
    buffer_load_dwordx4 v244, s[44:47], s64 offen lds
    s_mov_b32 exec_hi, -1
    v_mul_f32 v13, v10, v13
    v_cvt_pk_bf16_f32 v13, v13, v13
    v_lshlrev_b32 v13, 16, v13
    v_smfmac_f32_32x32x32_bf16 v[68:83], v[44:47], v[116:123], v32
    ds_read_b128 v[44:47], v35 offset:1280
    v_exp_f32 v128, v128
    v_exp_f32 v129, v129
    v_mul_f32 v13, v13, v11
    v_cvt_pk_bf16_f32 v13, v13, v13
    v_exp_f32 v130, v130
    v_exp_f32 v131, v131
    v_and_b32 v14, 0xffff0000, v13
    v_and_b32 v13, 0xffff, v13
    s_waitcnt lgkmcnt(1)
    v_smfmac_f32_32x32x32_bf16 v[52:67], v[48:51], v[92:99], v32
    v_exp_f32 v100, v100
    v_exp_f32 v101, v101
    ds_write_b32 v253, v13
    ds_write_b32 v253, v14 offset:128
    v_exp_f32 v102, v102
    v_exp_f32 v103, v103
    v_smfmac_f32_32x32x32_bf16 v[68:83], v[48:51], v[124:131], v32
    ds_read_b128 v[48:51], v35 offset:1920
    v_exp_f32 v104, v104
    v_exp_f32 v105, v105
    s_add_u32 m0, m0, 6144
    v_and_b32 v6, 3, v2
    v_lshlrev_b32 v8, 4, v3
    v_lshlrev_b32 v6, 7, v6
    v_exp_f32 v106, v106
    v_exp_f32 v107, v107
    v_add_u32 v8, 157184, v8
    v_lshrrev_b32 v7, 2, v2
    v_add_u32 v6, v6, v8
    v_mfma_f32_32x32x16_bf16 v[84:99], v[36:39], v[16:19], 0
    v_exp_f32 v108, v108
    v_exp_f32 v109, v109
    v_add_u32 v8, 512, v8
    v_lshlrev_b32 v9, 3, v3
    v_exp_f32 v110, v110
    v_exp_f32 v111, v111
    v_cmp_eq_u32 vcc, 0, v7
    v_mfma_f32_32x32x16_bf16 v[116:131], v[36:39], v[24:27], 0
    ds_read_b128 v[36:39], v33 offset:3072
    v_exp_f32 v112, v112
    v_exp_f32 v113, v113
    s_add_u32 s64, s64, 82944
    v_cndmask_b32 v10, v8, v6, vcc
    v_sub_u32 v11, v10, v9
    v_exp_f32 v114, v114
    v_exp_f32 v115, v115
    v_mfma_f32_32x32x8_bf16 v[84:99], v[42:43], v[20:21], v[84:99]
    v_exp_f32 v132, v132
    v_exp_f32 v133, v133
    ds_read_b128 v[220:223], v10
    ds_read_b64 v[224:225], v11 offset:64
    v_exp_f32 v134, v134
    v_exp_f32 v135, v135
    v_cmp_eq_u32 vcc, 1, v7
    v_mfma_f32_32x32x8_bf16 v[116:131], v[42:43], v[28:29], v[116:131]
    v_exp_f32 v136, v136
    v_exp_f32 v137, v137
    v_cndmask_b32 v10, v8, v6, vcc
    v_sub_u32 v11, v10, v9
    v_exp_f32 v138, v138
    v_exp_f32 v139, v139
    s_mov_b32 exec_hi, 0xffff
    buffer_load_dwordx4 v244, s[44:47], s64 offen lds
    s_mov_b32 exec_hi, -1
    ds_read_b128 v[226:229], v10
    ds_read_b64 v[230:231], v11 offset:64
    s_waitcnt lgkmcnt(8)
    v_smfmac_f32_32x32x32_bf16 v[52:67], v[44:47], v[100:107], v32
    v_exp_f32 v140, v140
    v_exp_f32 v141, v141
    v_exp_f32 v142, v142
    v_exp_f32 v143, v143
    v_cmp_eq_u32 vcc, 2, v7
    v_smfmac_f32_32x32x32_bf16 v[68:83], v[44:47], v[132:139], v32
    ds_read_b128 v[44:47], v35 offset:2560
    v_exp_f32 v144, v144
    v_exp_f32 v145, v145
    v_cndmask_b32 v10, v8, v6, vcc
    v_sub_u32 v11, v10, v9
    v_exp_f32 v146, v146
    v_exp_f32 v147, v147
    s_add_u32 m0, m0, 6144
    ds_read_b128 v[232:235], v10
    ds_read_b64 v[236:237], v11 offset:64
    s_waitcnt lgkmcnt(7)
    v_smfmac_f32_32x32x32_bf16 v[52:67], v[48:51], v[108:115], v32
    v_exp_f32 v84, v84
    v_exp_f32 v85, v85
    v_exp_f32 v86, v86
    v_exp_f32 v87, v87
    s_waitcnt lgkmcnt(0)
    v_smfmac_f32_32x32x32_bf16 v[68:83], v[48:51], v[140:147], v32
    ds_read_b128 v[48:51], v35 offset:3200
    v_exp_f32 v88, v88
    v_exp_f32 v89, v89
    v_exp_f32 v90, v90
    v_exp_f32 v91, v91
    v_mfma_f32_16x16x32_bf16 v[212:215], v[220:223], v[194:197], 0
    v_mfma_f32_32x32x16_bf16 v[100:115], v[36:39], v[16:19], 0
    v_exp_f32 v92, v92
    v_exp_f32 v93, v93
    s_add_u32 s64, s64, 82944
    v_mfma_f32_16x16x16_bf16 v[216:219], v[224:225], v[198:199], 0
    v_exp_f32 v94, v94
    v_exp_f32 v95, v95
    v_mfma_f32_16x16x32_bf16 v[212:215], v[226:229], v[200:203], v[212:215]
    v_mfma_f32_32x32x16_bf16 v[132:147], v[36:39], v[24:27], 0
    ds_read_b128 v[36:39], v33 offset:4096
    v_exp_f32 v96, v96
    v_exp_f32 v97, v97
    v_mfma_f32_16x16x16_bf16 v[216:219], v[230:231], v[204:205], v[216:219]
    v_exp_f32 v98, v98
    v_exp_f32 v99, v99
    v_mfma_f32_32x32x8_bf16 v[100:115], v[42:43], v[22:23], v[100:115]
    v_exp_f32 v116, v116
    v_exp_f32 v117, v117
    s_mov_b32 exec_hi, 0xffff
    buffer_load_dwordx4 v244, s[44:47], s64 offen lds
    s_mov_b32 exec_hi, -1
    v_mfma_f32_16x16x32_bf16 v[212:215], v[232:235], v[206:209], v[212:215]
    v_exp_f32 v118, v118
    v_exp_f32 v119, v119
    v_mfma_f32_16x16x16_bf16 v[216:219], v[236:237], v[210:211], v[216:219]
    v_mfma_f32_32x32x8_bf16 v[132:147], v[42:43], v[30:31], v[132:147]
    ds_read_b128 v[40:43], v34 offset:512
    v_exp_f32 v120, v120
    v_exp_f32 v121, v121
    v_exp_f32 v122, v122
    v_exp_f32 v123, v123
    v_smfmac_f32_32x32x32_bf16 v[52:67], v[44:47], v[84:91], v32
    v_exp_f32 v124, v124
    v_exp_f32 v125, v125
    v_pk_add_f32 v[212:213], v[212:213], v[216:217]
    v_pk_add_f32 v[214:215], v[214:215], v[218:219]
    v_exp_f32 v126, v126
    v_exp_f32 v127, v127
    s_add_u32 m0, m0, s66
    v_smfmac_f32_32x32x32_bf16 v[68:83], v[44:47], v[116:123], v32
    ds_read_b128 v[44:47], v35 offset:3840
    v_exp_f32 v128, v128
    v_exp_f32 v129, v129
    buffer_atomic_add_f32 v212, v254, s[80:83], s29 offen offset:0
    v_exp_f32 v130, v130
    v_exp_f32 v131, v131
    buffer_atomic_add_f32 v213, v254, s[80:83], s29 offen offset:1152
    s_waitcnt lgkmcnt(1)
    v_smfmac_f32_32x32x32_bf16 v[52:67], v[48:51], v[92:99], v32
    v_exp_f32 v100, v100
    v_exp_f32 v101, v101
    buffer_atomic_add_f32 v214, v254, s[80:83], s29 offen offset:2304
    v_exp_f32 v102, v102
    v_exp_f32 v103, v103
    s_add_u32 s64, s64, 82944
    buffer_atomic_add_f32 v215, v254, s[80:83], s29 offen offset:3456
    v_smfmac_f32_32x32x32_bf16 v[68:83], v[48:51], v[124:131], v32
    ds_read_b128 v[48:51], v35 offset:4480
    v_exp_f32 v104, v104
    v_exp_f32 v105, v105
    v_exp_f32 v106, v106
    v_exp_f32 v107, v107
    v_mfma_f32_32x32x16_bf16 v[84:99], v[36:39], v[16:19], 0
    v_exp_f32 v108, v108
    v_exp_f32 v109, v109
    v_exp_f32 v110, v110
    v_exp_f32 v111, v111
    v_mfma_f32_32x32x16_bf16 v[116:131], v[36:39], v[24:27], 0
    ds_read_b128 v[36:39], v33 offset:5120
    v_exp_f32 v112, v112
    v_exp_f32 v113, v113
    s_mov_b32 exec_hi, 0xffff
    buffer_load_dwordx4 v244, s[44:47], s64 offen lds
    s_mov_b32 exec_hi, -1
    v_exp_f32 v114, v114
    v_exp_f32 v115, v115
    v_mfma_f32_32x32x8_bf16 v[84:99], v[40:41], v[20:21], v[84:99]
    v_exp_f32 v132, v132
    v_exp_f32 v133, v133
    v_exp_f32 v134, v134
    v_exp_f32 v135, v135
    v_mfma_f32_32x32x8_bf16 v[116:131], v[40:41], v[28:29], v[116:131]
    v_exp_f32 v136, v136
    v_exp_f32 v137, v137
    v_exp_f32 v138, v138
    v_exp_f32 v139, v139
    s_add_u32 m0, m0, s67
    s_waitcnt lgkmcnt(2)
    v_smfmac_f32_32x32x32_bf16 v[52:67], v[44:47], v[100:107], v32
    v_exp_f32 v140, v140
    v_exp_f32 v141, v141
    global_load_dword v239, v15, s[30:31]
    v_exp_f32 v142, v142
    v_exp_f32 v143, v143
    v_smfmac_f32_32x32x32_bf16 v[68:83], v[44:47], v[132:139], v32
    ds_read_b128 v[44:47], v35 offset:5120
    v_exp_f32 v144, v144
    v_exp_f32 v145, v145
    v_exp_f32 v146, v146
    v_exp_f32 v147, v147
    s_add_u32 s64, s64, 82944
    s_waitcnt lgkmcnt(1)
    v_smfmac_f32_32x32x32_bf16 v[52:67], v[48:51], v[108:115], v32
    v_exp_f32 v84, v84
    v_exp_f32 v85, v85
    v_exp_f32 v86, v86
    v_exp_f32 v87, v87
    v_smfmac_f32_32x32x32_bf16 v[68:83], v[48:51], v[140:147], v32
    ds_read_b128 v[48:51], v35 offset:5760
    v_exp_f32 v88, v88
    v_exp_f32 v89, v89
    v_exp_f32 v90, v90
    v_exp_f32 v91, v91
    v_mfma_f32_32x32x16_bf16 v[100:115], v[36:39], v[16:19], 0
    v_exp_f32 v92, v92
    v_exp_f32 v93, v93
    s_mov_b32 exec_hi, 0xffff
    buffer_load_dwordx4 v244, s[44:47], s64 offen lds
    s_mov_b32 exec_hi, -1
    v_exp_f32 v94, v94
    v_exp_f32 v95, v95
    v_mfma_f32_32x32x16_bf16 v[132:147], v[36:39], v[24:27], 0
    ds_read_b128 v[36:39], v33 offset:6144
    v_exp_f32 v96, v96
    v_exp_f32 v97, v97
    v_exp_f32 v98, v98
    v_exp_f32 v99, v99
    v_mfma_f32_32x32x8_bf16 v[100:115], v[40:41], v[22:23], v[100:115]
    v_exp_f32 v116, v116
    v_exp_f32 v117, v117
    s_add_u32 m0, m0, 6144
    v_exp_f32 v118, v118
    v_exp_f32 v119, v119
    v_mfma_f32_32x32x8_bf16 v[132:147], v[40:41], v[30:31], v[132:147]
    v_exp_f32 v120, v120
    v_exp_f32 v121, v121
    v_exp_f32 v122, v122
    v_exp_f32 v123, v123
    s_waitcnt lgkmcnt(2)
    v_smfmac_f32_32x32x32_bf16 v[52:67], v[44:47], v[84:91], v32
    v_exp_f32 v124, v124
    v_exp_f32 v125, v125
    v_exp_f32 v126, v126
    v_exp_f32 v127, v127
    s_add_u32 s64, s64, 82944
    v_smfmac_f32_32x32x32_bf16 v[68:83], v[44:47], v[116:123], v32
    ds_read_b128 v[44:47], v35 offset:6400
    v_exp_f32 v128, v128
    v_exp_f32 v129, v129
    v_exp_f32 v130, v130
    v_exp_f32 v131, v131
    s_waitcnt lgkmcnt(1)
    v_smfmac_f32_32x32x32_bf16 v[52:67], v[48:51], v[92:99], v32
    v_exp_f32 v100, v100
    v_exp_f32 v101, v101
    v_exp_f32 v102, v102
    v_exp_f32 v103, v103
    s_mov_b32 exec_hi, 0xffff
    buffer_load_dwordx4 v244, s[44:47], s64 offen lds
    s_mov_b32 exec_hi, -1
    v_smfmac_f32_32x32x32_bf16 v[68:83], v[48:51], v[124:131], v32
    ds_read_b128 v[48:51], v35 offset:7040
    v_exp_f32 v104, v104
    v_exp_f32 v105, v105
    v_exp_f32 v106, v106
    v_exp_f32 v107, v107
    v_mfma_f32_32x32x16_bf16 v[84:99], v[36:39], v[16:19], 0
    v_exp_f32 v108, v108
    v_exp_f32 v109, v109
    v_exp_f32 v110, v110
    v_exp_f32 v111, v111
    v_mfma_f32_32x32x16_bf16 v[116:131], v[36:39], v[24:27], 0
    ds_read_b128 v[36:39], v33 offset:7168
    v_exp_f32 v112, v112
    v_exp_f32 v113, v113
    s_add_u32 m0, m0, 6144
    v_exp_f32 v114, v114
    v_exp_f32 v115, v115
    v_mfma_f32_32x32x8_bf16 v[84:99], v[42:43], v[20:21], v[84:99]
    v_exp_f32 v132, v132
    v_exp_f32 v133, v133
    v_exp_f32 v134, v134
    v_exp_f32 v135, v135
    v_mfma_f32_32x32x8_bf16 v[116:131], v[42:43], v[28:29], v[116:131]
    v_exp_f32 v136, v136
    v_exp_f32 v137, v137
    s_add_u32 s64, s64, 82944
    v_exp_f32 v138, v138
    v_exp_f32 v139, v139
    s_waitcnt lgkmcnt(2)
    v_smfmac_f32_32x32x32_bf16 v[52:67], v[44:47], v[100:107], v32
    v_exp_f32 v140, v140
    v_exp_f32 v141, v141
    v_exp_f32 v142, v142
    v_exp_f32 v143, v143
    v_smfmac_f32_32x32x32_bf16 v[68:83], v[44:47], v[132:139], v32
    ds_read_b128 v[44:47], v35 offset:7680
    v_exp_f32 v144, v144
    v_exp_f32 v145, v145
    v_exp_f32 v146, v146
    v_exp_f32 v147, v147
    s_mov_b32 exec_hi, 0xffff
    buffer_load_dwordx4 v244, s[44:47], s64 offen lds
    s_mov_b32 exec_hi, -1
    s_waitcnt lgkmcnt(1)
    v_smfmac_f32_32x32x32_bf16 v[52:67], v[48:51], v[108:115], v32
    v_exp_f32 v84, v84
    v_exp_f32 v85, v85
    v_exp_f32 v86, v86
    v_exp_f32 v87, v87
    v_smfmac_f32_32x32x32_bf16 v[68:83], v[48:51], v[140:147], v32
    ds_read_b128 v[48:51], v35 offset:8320
    v_exp_f32 v88, v88
    v_exp_f32 v89, v89
    v_exp_f32 v90, v90
    v_exp_f32 v91, v91
    s_add_u32 m0, m0, 6144
    v_mfma_f32_32x32x16_bf16 v[100:115], v[36:39], v[16:19], 0
    v_exp_f32 v92, v92
    v_exp_f32 v93, v93
    buffer_load_dwordx4 v[148:151], v248, s[32:35], s51 offen
    v_exp_f32 v94, v94
    v_exp_f32 v95, v95
    v_mfma_f32_32x32x16_bf16 v[132:147], v[36:39], v[24:27], 0
    ds_read_b128 v[36:39], v33 offset:8192
    v_exp_f32 v96, v96
    v_exp_f32 v97, v97
    v_exp_f32 v98, v98
    v_exp_f32 v99, v99
    buffer_load_dwordx2 v[152:153], v249, s[32:35], s51 offen offset:64
    v_mfma_f32_32x32x8_bf16 v[100:115], v[42:43], v[22:23], v[100:115]
    v_exp_f32 v116, v116
    v_exp_f32 v117, v117
    s_mov_b32 exec_hi, 0xffff
    buffer_load_dwordx4 v245, s[44:47], s65 offen lds
    s_mov_b32 exec_hi, -1
    v_exp_f32 v118, v118
    v_exp_f32 v119, v119
    v_mfma_f32_32x32x8_bf16 v[132:147], v[42:43], v[30:31], v[132:147]
    ds_read_b128 v[40:43], v34 offset:1024
    v_exp_f32 v120, v120
    v_exp_f32 v121, v121
    v_exp_f32 v122, v122
    v_exp_f32 v123, v123
    s_waitcnt lgkmcnt(3)
    v_smfmac_f32_32x32x32_bf16 v[52:67], v[44:47], v[84:91], v32
    v_exp_f32 v124, v124
    v_exp_f32 v125, v125
    v_exp_f32 v126, v126
    v_exp_f32 v127, v127
    v_smfmac_f32_32x32x32_bf16 v[68:83], v[44:47], v[116:123], v32
    ds_read_b128 v[44:47], v35 offset:8960
    v_exp_f32 v128, v128
    v_exp_f32 v129, v129
    s_waitcnt vmcnt(8)
    s_mov_b64 exec, 1
    ds_add_rtn_u32 v164, v160, v161
    s_mov_b64 exec, -1
    v_exp_f32 v130, v130
    v_exp_f32 v131, v131
    s_waitcnt lgkmcnt(2)
    v_smfmac_f32_32x32x32_bf16 v[52:67], v[48:51], v[92:99], v32
    v_exp_f32 v100, v100
    v_exp_f32 v101, v101
    v_exp_f32 v102, v102
    v_exp_f32 v103, v103
    v_smfmac_f32_32x32x32_bf16 v[68:83], v[48:51], v[124:131], v32
    ds_read_b128 v[48:51], v35 offset:9600
    v_exp_f32 v104, v104
    v_exp_f32 v105, v105
    s_waitcnt lgkmcnt(1)
    v_readfirstlane_b32 s71, v164
    v_exp_f32 v106, v106
    v_exp_f32 v107, v107
    v_mfma_f32_32x32x16_bf16 v[84:99], v[36:39], v[16:19], 0
    v_exp_f32 v108, v108
    v_exp_f32 v109, v109
    s_cmp_lg_u32 s71, 7
    s_cbranch_scc1 L_mflag_55
    buffer_store_dword v162, v163, s[80:83], s70 offen sc1
L_mflag_55:
    v_exp_f32 v110, v110
    v_exp_f32 v111, v111
    v_mfma_f32_32x32x16_bf16 v[116:131], v[36:39], v[24:27], 0
    ds_read_b128 v[36:39], v33 offset:9216
    v_exp_f32 v112, v112
    v_exp_f32 v113, v113
    v_exp_f32 v114, v114
    v_exp_f32 v115, v115
    v_mfma_f32_32x32x8_bf16 v[84:99], v[40:41], v[20:21], v[84:99]
    v_exp_f32 v132, v132
    v_exp_f32 v133, v133
    v_exp_f32 v134, v134
    v_exp_f32 v135, v135
    v_mfma_f32_32x32x8_bf16 v[116:131], v[40:41], v[28:29], v[116:131]
    v_exp_f32 v136, v136
    v_exp_f32 v137, v137
    v_exp_f32 v138, v138
    v_exp_f32 v139, v139
    v_smfmac_f32_32x32x32_bf16 v[52:67], v[44:47], v[100:107], v32
    v_exp_f32 v140, v140
    v_exp_f32 v141, v141
    v_exp_f32 v142, v142
    v_exp_f32 v143, v143
    v_smfmac_f32_32x32x32_bf16 v[68:83], v[44:47], v[132:139], v32
    ds_read_b128 v[44:47], v35 offset:10240
    v_exp_f32 v144, v144
    v_exp_f32 v145, v145
    v_exp_f32 v146, v146
    v_exp_f32 v147, v147
    v_add_u32 v33, 8192, v33
    v_add_u32 v34, 1024, v34
    v_add_u32 v35, 10240, v35
    s_waitcnt lgkmcnt(1)
    v_smfmac_f32_32x32x32_bf16 v[52:67], v[48:51], v[108:115], v32
    v_smfmac_f32_32x32x32_bf16 v[68:83], v[48:51], v[140:147], v32
    s_setprio 0
    s_branch L_att_done_47
L_att_role_46:
    s_waitcnt vmcnt(0) lgkmcnt(0)
    v_readfirstlane_b32 s88, v9
    s_barrier
    ds_read_b128 v[36:39], v33
    ds_read_b128 v[40:43], v34
    ds_read_b128 v[44:47], v35
    s_waitcnt lgkmcnt(1)
    v_mfma_f32_32x32x16_bf16 v[84:99], v[36:39], v[16:19], 0
    v_mfma_f32_32x32x16_bf16 v[116:131], v[36:39], v[24:27], 0
    ds_read_b128 v[36:39], v33 offset:1024
    s_nop 7
    v_mfma_f32_32x32x8_bf16 v[84:99], v[40:41], v[20:21], v[84:99]
    v_mfma_f32_32x32x8_bf16 v[116:131], v[40:41], v[28:29], v[116:131]
    s_waitcnt lgkmcnt(0)
    s_cmp_eq_u32 s48, 0
    s_cbranch_scc1 L_p0_58
    s_setprio 1
    s_branch L_p1_59
L_p0_58:
    s_setprio 0
L_p1_59:
    s_nop 9
    .p2align 6
    v_smfmac_f32_32x32x32_bf16 v[52:67], v[48:51], v[108:115], v32
    v_exp_f32 v84, v84
    v_exp_f32 v85, v85
    s_mov_b32 m0, s64
    v_exp_f32 v86, v86
    v_exp_f32 v87, v87
    v_smfmac_f32_32x32x32_bf16 v[68:83], v[48:51], v[140:147], v32
    ds_read_b128 v[48:51], v35 offset:640
    v_exp_f32 v88, v88
    v_exp_f32 v89, v89
    buffer_load_dwordx4 v5, s[80:83], s64 offen sc1 lds
    v_exp_f32 v90, v90
    v_exp_f32 v91, v91
    v_mfma_f32_32x32x16_bf16 v[100:115], v[36:39], v[16:19], 0
    v_exp_f32 v92, v92
    v_exp_f32 v93, v93
    buffer_load_dwordx4 v5, s[80:83], s64 offen offset:1024 sc1 lds
    v_exp_f32 v94, v94
    v_exp_f32 v95, v95
    v_mfma_f32_32x32x16_bf16 v[132:147], v[36:39], v[24:27], 0
    ds_read_b128 v[36:39], v33 offset:2048
    v_exp_f32 v96, v96
    v_exp_f32 v97, v97
    buffer_load_dwordx4 v5, s[80:83], s64 offen offset:2048 sc1 lds
    v_exp_f32 v98, v98
    v_exp_f32 v99, v99
    v_mfma_f32_32x32x8_bf16 v[100:115], v[40:41], v[22:23], v[100:115]
    v_exp_f32 v116, v116
    v_exp_f32 v117, v117
    buffer_load_dwordx4 v5, s[80:83], s64 offen offset:3072 sc1 lds
    v_exp_f32 v118, v118
    v_exp_f32 v119, v119
    v_mfma_f32_32x32x8_bf16 v[132:147], v[40:41], v[30:31], v[132:147]
    v_exp_f32 v120, v120
    v_exp_f32 v121, v121
    s_mov_b32 m0, s66
    v_exp_f32 v122, v122
    v_exp_f32 v123, v123
    s_waitcnt lgkmcnt(2)
    v_smfmac_f32_32x32x32_bf16 v[52:67], v[44:47], v[84:91], v32
    v_exp_f32 v124, v124
    v_exp_f32 v125, v125
    buffer_load_dwordx4 v5, s[80:83], s66 offen sc1 lds
    v_exp_f32 v126, v126
    v_exp_f32 v127, v127
    v_smfmac_f32_32x32x32_bf16 v[68:83], v[44:47], v[116:123], v32
    ds_read_b128 v[44:47], v35 offset:1280
    v_exp_f32 v128, v128
    v_exp_f32 v129, v129
    buffer_load_dwordx4 v5, s[80:83], s66 offen offset:1024 sc1 lds
    v_exp_f32 v130, v130
    v_exp_f32 v131, v131
    s_waitcnt lgkmcnt(1)
    v_smfmac_f32_32x32x32_bf16 v[52:67], v[48:51], v[92:99], v32
    v_exp_f32 v100, v100
    v_exp_f32 v101, v101
    buffer_load_dwordx4 v5, s[80:83], s66 offen offset:2048 sc1 lds
    v_exp_f32 v102, v102
    v_exp_f32 v103, v103
    v_smfmac_f32_32x32x32_bf16 v[68:83], v[48:51], v[124:131], v32
    ds_read_b128 v[48:51], v35 offset:1920
    v_exp_f32 v104, v104
    v_exp_f32 v105, v105
    buffer_load_dwordx4 v5, s[80:83], s66 offen offset:3072 sc1 lds
    v_exp_f32 v106, v106
    v_exp_f32 v107, v107
    v_mfma_f32_32x32x16_bf16 v[84:99], v[36:39], v[16:19], 0
    v_exp_f32 v108, v108
    v_exp_f32 v109, v109
    s_mov_b32 m0, s65
    v_exp_f32 v110, v110
    v_exp_f32 v111, v111
    v_mfma_f32_32x32x16_bf16 v[116:131], v[36:39], v[24:27], 0
    ds_read_b128 v[36:39], v33 offset:3072
    v_exp_f32 v112, v112
    v_exp_f32 v113, v113
    buffer_load_dwordx4 v5, s[80:83], s65 offen sc1 lds
    v_exp_f32 v114, v114
    v_exp_f32 v115, v115
    v_mfma_f32_32x32x8_bf16 v[84:99], v[42:43], v[20:21], v[84:99]
    v_exp_f32 v132, v132
    v_exp_f32 v133, v133
    buffer_load_dwordx4 v5, s[80:83], s65 offen offset:1024 sc1 lds
    v_exp_f32 v134, v134
    v_exp_f32 v135, v135
    v_mfma_f32_32x32x8_bf16 v[116:131], v[42:43], v[28:29], v[116:131]
    v_exp_f32 v136, v136
    v_exp_f32 v137, v137
    s_mov_b32 m0, s67
    v_exp_f32 v138, v138
    v_exp_f32 v139, v139
    s_waitcnt lgkmcnt(2)
    v_smfmac_f32_32x32x32_bf16 v[52:67], v[44:47], v[100:107], v32
    v_exp_f32 v140, v140
    v_exp_f32 v141, v141
    buffer_load_dwordx4 v5, s[80:83], s67 offen sc1 lds
    v_exp_f32 v142, v142
    v_exp_f32 v143, v143
    v_smfmac_f32_32x32x32_bf16 v[68:83], v[44:47], v[132:139], v32
    ds_read_b128 v[44:47], v35 offset:2560
    v_exp_f32 v144, v144
    v_exp_f32 v145, v145
    buffer_load_dwordx4 v5, s[80:83], s67 offen offset:1024 sc1 lds
    v_exp_f32 v146, v146
    v_exp_f32 v147, v147
    s_waitcnt lgkmcnt(1)
    v_smfmac_f32_32x32x32_bf16 v[52:67], v[48:51], v[108:115], v32
    v_exp_f32 v84, v84
    v_exp_f32 v85, v85
    buffer_load_dwordx4 v5, s[80:83], s67 offen offset:2048 sc1 lds
    v_exp_f32 v86, v86
    v_exp_f32 v87, v87
    v_smfmac_f32_32x32x32_bf16 v[68:83], v[48:51], v[140:147], v32
    ds_read_b128 v[48:51], v35 offset:3200
    v_exp_f32 v88, v88
    v_exp_f32 v89, v89
    buffer_load_dwordx4 v5, s[80:83], s67 offen offset:3072 sc1 lds
    v_exp_f32 v90, v90
    v_exp_f32 v91, v91
    v_mfma_f32_32x32x16_bf16 v[100:115], v[36:39], v[16:19], 0
    v_exp_f32 v92, v92
    v_exp_f32 v93, v93
    v_exp_f32 v94, v94
    v_exp_f32 v95, v95
    v_mfma_f32_32x32x16_bf16 v[132:147], v[36:39], v[24:27], 0
    ds_read_b128 v[36:39], v33 offset:4096
    v_exp_f32 v96, v96
    v_exp_f32 v97, v97
    v_exp_f32 v98, v98
    v_exp_f32 v99, v99
    v_mfma_f32_32x32x8_bf16 v[100:115], v[42:43], v[22:23], v[100:115]
    v_exp_f32 v116, v116
    v_exp_f32 v117, v117
    v_exp_f32 v118, v118
    v_exp_f32 v119, v119
    v_mfma_f32_32x32x8_bf16 v[132:147], v[42:43], v[30:31], v[132:147]
    ds_read_b128 v[40:43], v34 offset:512
    v_exp_f32 v120, v120
    v_exp_f32 v121, v121
    v_exp_f32 v122, v122
    v_exp_f32 v123, v123
    s_waitcnt lgkmcnt(3)
    v_smfmac_f32_32x32x32_bf16 v[52:67], v[44:47], v[84:91], v32
    v_exp_f32 v124, v124
    v_exp_f32 v125, v125
    v_exp_f32 v126, v126
    v_exp_f32 v127, v127
    v_smfmac_f32_32x32x32_bf16 v[68:83], v[44:47], v[116:123], v32
    ds_read_b128 v[44:47], v35 offset:3840
    v_exp_f32 v128, v128
    v_exp_f32 v129, v129
    v_exp_f32 v130, v130
    v_exp_f32 v131, v131
    s_waitcnt lgkmcnt(1)
    v_smfmac_f32_32x32x32_bf16 v[52:67], v[48:51], v[92:99], v32
    v_exp_f32 v100, v100
    v_exp_f32 v101, v101
    v_exp_f32 v102, v102
    v_exp_f32 v103, v103
    v_smfmac_f32_32x32x32_bf16 v[68:83], v[48:51], v[124:131], v32
    ds_read_b128 v[48:51], v35 offset:4480
    v_exp_f32 v104, v104
    v_exp_f32 v105, v105
    v_exp_f32 v106, v106
    v_exp_f32 v107, v107
    v_mfma_f32_32x32x16_bf16 v[84:99], v[36:39], v[16:19], 0
    v_exp_f32 v108, v108
    v_exp_f32 v109, v109
    v_exp_f32 v110, v110
    v_exp_f32 v111, v111
    v_mfma_f32_32x32x16_bf16 v[116:131], v[36:39], v[24:27], 0
    ds_read_b128 v[36:39], v33 offset:5120
    v_exp_f32 v112, v112
    v_exp_f32 v113, v113
    v_exp_f32 v114, v114
    v_exp_f32 v115, v115
    v_mfma_f32_32x32x8_bf16 v[84:99], v[40:41], v[20:21], v[84:99]
    v_exp_f32 v132, v132
    v_exp_f32 v133, v133
    v_exp_f32 v134, v134
    v_exp_f32 v135, v135
    v_mfma_f32_32x32x8_bf16 v[116:131], v[40:41], v[28:29], v[116:131]
    v_exp_f32 v136, v136
    v_exp_f32 v137, v137
    v_exp_f32 v138, v138
    v_exp_f32 v139, v139
    s_waitcnt lgkmcnt(2)
    v_smfmac_f32_32x32x32_bf16 v[52:67], v[44:47], v[100:107], v32
    v_exp_f32 v140, v140
    v_exp_f32 v141, v141
    v_exp_f32 v142, v142
    v_exp_f32 v143, v143
    v_smfmac_f32_32x32x32_bf16 v[68:83], v[44:47], v[132:139], v32
    ds_read_b128 v[44:47], v35 offset:5120
    v_exp_f32 v144, v144
    v_exp_f32 v145, v145
    v_exp_f32 v146, v146
    v_exp_f32 v147, v147
    s_waitcnt lgkmcnt(1)
    v_smfmac_f32_32x32x32_bf16 v[52:67], v[48:51], v[108:115], v32
    v_exp_f32 v84, v84
    v_exp_f32 v85, v85
    v_exp_f32 v86, v86
    v_exp_f32 v87, v87
    v_smfmac_f32_32x32x32_bf16 v[68:83], v[48:51], v[140:147], v32
    ds_read_b128 v[48:51], v35 offset:5760
    v_exp_f32 v88, v88
    v_exp_f32 v89, v89
    v_exp_f32 v90, v90
    v_exp_f32 v91, v91
    v_mfma_f32_32x32x16_bf16 v[100:115], v[36:39], v[16:19], 0
    v_exp_f32 v92, v92
    v_exp_f32 v93, v93
    v_exp_f32 v94, v94
    v_exp_f32 v95, v95
    v_mfma_f32_32x32x16_bf16 v[132:147], v[36:39], v[24:27], 0
    ds_read_b128 v[36:39], v33 offset:6144
    v_exp_f32 v96, v96
    v_exp_f32 v97, v97
    v_exp_f32 v98, v98
    v_exp_f32 v99, v99
    v_mfma_f32_32x32x8_bf16 v[100:115], v[40:41], v[22:23], v[100:115]
    v_exp_f32 v116, v116
    v_exp_f32 v117, v117
    v_exp_f32 v118, v118
    v_exp_f32 v119, v119
    v_mfma_f32_32x32x8_bf16 v[132:147], v[40:41], v[30:31], v[132:147]
    v_exp_f32 v120, v120
    v_exp_f32 v121, v121
    v_exp_f32 v122, v122
    v_exp_f32 v123, v123
    s_waitcnt lgkmcnt(2)
    v_smfmac_f32_32x32x32_bf16 v[52:67], v[44:47], v[84:91], v32
    v_exp_f32 v124, v124
    v_exp_f32 v125, v125
    v_exp_f32 v126, v126
    v_exp_f32 v127, v127
    v_smfmac_f32_32x32x32_bf16 v[68:83], v[44:47], v[116:123], v32
    ds_read_b128 v[44:47], v35 offset:6400
    v_exp_f32 v128, v128
    v_exp_f32 v129, v129
    s_waitcnt vmcnt(0)
    s_barrier
    v_exp_f32 v130, v130
    v_exp_f32 v131, v131
    s_waitcnt lgkmcnt(1)
    v_smfmac_f32_32x32x32_bf16 v[52:67], v[48:51], v[92:99], v32
    v_exp_f32 v100, v100
    v_exp_f32 v101, v101
    v_exp_f32 v102, v102
    v_exp_f32 v103, v103
    v_smfmac_f32_32x32x32_bf16 v[68:83], v[48:51], v[124:131], v32
    ds_read_b128 v[48:51], v35 offset:7040
    v_exp_f32 v104, v104
    v_exp_f32 v105, v105
    v_exp_f32 v106, v106
    v_exp_f32 v107, v107
    v_mfma_f32_32x32x16_bf16 v[84:99], v[36:39], v[16:19], 0
    v_exp_f32 v108, v108
    v_exp_f32 v109, v109
    v_exp_f32 v110, v110
    v_exp_f32 v111, v111
    v_mfma_f32_32x32x16_bf16 v[116:131], v[36:39], v[24:27], 0
    ds_read_b128 v[36:39], v33 offset:7168
    v_exp_f32 v112, v112
    v_exp_f32 v113, v113
    v_exp_f32 v114, v114
    v_exp_f32 v115, v115
    v_mfma_f32_32x32x8_bf16 v[84:99], v[42:43], v[20:21], v[84:99]
    v_exp_f32 v132, v132
    v_exp_f32 v133, v133
    v_exp_f32 v134, v134
    v_exp_f32 v135, v135
    v_mfma_f32_32x32x8_bf16 v[116:131], v[42:43], v[28:29], v[116:131]
    v_exp_f32 v136, v136
    v_exp_f32 v137, v137
    v_exp_f32 v138, v138
    v_exp_f32 v139, v139
    s_waitcnt lgkmcnt(2)
    v_smfmac_f32_32x32x32_bf16 v[52:67], v[44:47], v[100:107], v32
    v_exp_f32 v140, v140
    v_exp_f32 v141, v141
    v_exp_f32 v142, v142
    v_exp_f32 v143, v143
    v_smfmac_f32_32x32x32_bf16 v[68:83], v[44:47], v[132:139], v32
    ds_read_b128 v[44:47], v35 offset:7680
    v_exp_f32 v144, v144
    v_exp_f32 v145, v145
    v_exp_f32 v146, v146
    v_exp_f32 v147, v147
    s_waitcnt lgkmcnt(1)
    v_smfmac_f32_32x32x32_bf16 v[52:67], v[48:51], v[108:115], v32
    v_exp_f32 v84, v84
    v_exp_f32 v85, v85
    v_exp_f32 v86, v86
    v_exp_f32 v87, v87
    v_smfmac_f32_32x32x32_bf16 v[68:83], v[48:51], v[140:147], v32
    ds_read_b128 v[48:51], v35 offset:8320
    v_exp_f32 v88, v88
    v_exp_f32 v89, v89
    v_exp_f32 v90, v90
    v_exp_f32 v91, v91
    v_mfma_f32_32x32x16_bf16 v[100:115], v[36:39], v[16:19], 0
    v_exp_f32 v92, v92
    v_exp_f32 v93, v93
    v_exp_f32 v94, v94
    v_exp_f32 v95, v95
    v_mfma_f32_32x32x16_bf16 v[132:147], v[36:39], v[24:27], 0
    ds_read_b128 v[36:39], v33 offset:8192
    v_exp_f32 v96, v96
    v_exp_f32 v97, v97
    v_exp_f32 v98, v98
    v_exp_f32 v99, v99
    v_mfma_f32_32x32x8_bf16 v[100:115], v[42:43], v[22:23], v[100:115]
    v_exp_f32 v116, v116
    v_exp_f32 v117, v117
    v_exp_f32 v118, v118
    v_exp_f32 v119, v119
    v_mfma_f32_32x32x8_bf16 v[132:147], v[42:43], v[30:31], v[132:147]
    ds_read_b128 v[40:43], v34 offset:1024
    v_exp_f32 v120, v120
    v_exp_f32 v121, v121
    v_exp_f32 v122, v122
    v_exp_f32 v123, v123
    s_waitcnt lgkmcnt(3)
    v_smfmac_f32_32x32x32_bf16 v[52:67], v[44:47], v[84:91], v32
    v_exp_f32 v124, v124
    v_exp_f32 v125, v125
    v_exp_f32 v126, v126
    v_exp_f32 v127, v127
    v_smfmac_f32_32x32x32_bf16 v[68:83], v[44:47], v[116:123], v32
    ds_read_b128 v[44:47], v35 offset:8960
    v_exp_f32 v128, v128
    v_exp_f32 v129, v129
    v_exp_f32 v130, v130
    v_exp_f32 v131, v131
    s_waitcnt lgkmcnt(1)
    v_smfmac_f32_32x32x32_bf16 v[52:67], v[48:51], v[92:99], v32
    v_exp_f32 v100, v100
    v_exp_f32 v101, v101
    v_exp_f32 v102, v102
    v_exp_f32 v103, v103
    v_smfmac_f32_32x32x32_bf16 v[68:83], v[48:51], v[124:131], v32
    ds_read_b128 v[48:51], v35 offset:9600
    v_exp_f32 v104, v104
    v_exp_f32 v105, v105
    v_exp_f32 v106, v106
    v_exp_f32 v107, v107
    v_mfma_f32_32x32x16_bf16 v[84:99], v[36:39], v[16:19], 0
    v_exp_f32 v108, v108
    v_exp_f32 v109, v109
    v_exp_f32 v110, v110
    v_exp_f32 v111, v111
    v_mfma_f32_32x32x16_bf16 v[116:131], v[36:39], v[24:27], 0
    ds_read_b128 v[36:39], v33 offset:9216
    v_exp_f32 v112, v112
    v_exp_f32 v113, v113
    v_exp_f32 v114, v114
    v_exp_f32 v115, v115
    v_mfma_f32_32x32x8_bf16 v[84:99], v[40:41], v[20:21], v[84:99]
    v_exp_f32 v132, v132
    v_exp_f32 v133, v133
    v_exp_f32 v134, v134
    v_exp_f32 v135, v135
    v_mfma_f32_32x32x8_bf16 v[116:131], v[40:41], v[28:29], v[116:131]
    v_exp_f32 v136, v136
    v_exp_f32 v137, v137
    v_exp_f32 v138, v138
    v_exp_f32 v139, v139
    s_waitcnt lgkmcnt(2)
    v_smfmac_f32_32x32x32_bf16 v[52:67], v[44:47], v[100:107], v32
    v_exp_f32 v140, v140
    v_exp_f32 v141, v141
    v_exp_f32 v142, v142
    v_exp_f32 v143, v143
    v_smfmac_f32_32x32x32_bf16 v[68:83], v[44:47], v[132:139], v32
    ds_read_b128 v[44:47], v35 offset:10240
    v_exp_f32 v144, v144
    v_exp_f32 v145, v145
    v_exp_f32 v146, v146
    v_exp_f32 v147, v147
    v_add_u32 v33, 8192, v33
    v_add_u32 v34, 1024, v34
    v_add_u32 v35, 10240, v35
    s_waitcnt lgkmcnt(1)
    s_cmp_eq_u32 s48, 1
    s_cbranch_scc1 L_p0_60
    s_setprio 1
    s_branch L_p1_61
L_p0_60:
    s_setprio 0
L_p1_61:
    s_nop 3
    v_smfmac_f32_32x32x32_bf16 v[52:67], v[48:51], v[108:115], v32
    v_exp_f32 v84, v84
    v_exp_f32 v85, v85
    v_exp_f32 v86, v86
    v_exp_f32 v87, v87
    v_smfmac_f32_32x32x32_bf16 v[68:83], v[48:51], v[140:147], v32
    ds_read_b128 v[48:51], v35 offset:640
    v_exp_f32 v88, v88
    v_exp_f32 v89, v89
    v_exp_f32 v90, v90
    v_exp_f32 v91, v91
    v_mfma_f32_32x32x16_bf16 v[100:115], v[36:39], v[16:19], 0
    v_exp_f32 v92, v92
    v_exp_f32 v93, v93
    v_exp_f32 v94, v94
    v_exp_f32 v95, v95
    v_mfma_f32_32x32x16_bf16 v[132:147], v[36:39], v[24:27], 0
    ds_read_b128 v[36:39], v33 offset:2048
    v_exp_f32 v96, v96
    v_exp_f32 v97, v97
    v_exp_f32 v98, v98
    v_exp_f32 v99, v99
    v_mfma_f32_32x32x8_bf16 v[100:115], v[40:41], v[22:23], v[100:115]
    v_exp_f32 v116, v116
    v_exp_f32 v117, v117
    v_exp_f32 v118, v118
    v_exp_f32 v119, v119
    v_mfma_f32_32x32x8_bf16 v[132:147], v[40:41], v[30:31], v[132:147]
    v_exp_f32 v120, v120
    v_exp_f32 v121, v121
    v_exp_f32 v122, v122
    v_exp_f32 v123, v123
    s_waitcnt lgkmcnt(2)
    v_smfmac_f32_32x32x32_bf16 v[52:67], v[44:47], v[84:91], v32
    v_exp_f32 v124, v124
    v_exp_f32 v125, v125
    v_exp_f32 v126, v126
    v_exp_f32 v127, v127
    v_smfmac_f32_32x32x32_bf16 v[68:83], v[44:47], v[116:123], v32
    ds_read_b128 v[44:47], v35 offset:1280
    v_exp_f32 v128, v128
    v_exp_f32 v129, v129
    v_exp_f32 v130, v130
    v_exp_f32 v131, v131
    s_waitcnt lgkmcnt(1)
    v_smfmac_f32_32x32x32_bf16 v[52:67], v[48:51], v[92:99], v32
    v_exp_f32 v100, v100
    v_exp_f32 v101, v101
    v_exp_f32 v102, v102
    v_exp_f32 v103, v103
    v_smfmac_f32_32x32x32_bf16 v[68:83], v[48:51], v[124:131], v32
    ds_read_b128 v[48:51], v35 offset:1920
    v_exp_f32 v104, v104
    v_exp_f32 v105, v105
    v_exp_f32 v106, v106
    v_exp_f32 v107, v107
    v_mfma_f32_32x32x16_bf16 v[84:99], v[36:39], v[16:19], 0
    v_exp_f32 v108, v108
    v_exp_f32 v109, v109
    v_exp_f32 v110, v110
    v_exp_f32 v111, v111
    v_mfma_f32_32x32x16_bf16 v[116:131], v[36:39], v[24:27], 0
    ds_read_b128 v[36:39], v33 offset:3072
    v_exp_f32 v112, v112
    v_exp_f32 v113, v113
    v_exp_f32 v114, v114
    v_exp_f32 v115, v115
    v_mfma_f32_32x32x8_bf16 v[84:99], v[42:43], v[20:21], v[84:99]
    v_exp_f32 v132, v132
    v_exp_f32 v133, v133
    v_exp_f32 v134, v134
    v_exp_f32 v135, v135
    v_mfma_f32_32x32x8_bf16 v[116:131], v[42:43], v[28:29], v[116:131]
    v_exp_f32 v136, v136
    v_exp_f32 v137, v137
    v_exp_f32 v138, v138
    v_exp_f32 v139, v139
    s_waitcnt lgkmcnt(2)
    v_smfmac_f32_32x32x32_bf16 v[52:67], v[44:47], v[100:107], v32
    v_exp_f32 v140, v140
    v_exp_f32 v141, v141
    v_exp_f32 v142, v142
    v_exp_f32 v143, v143
    v_smfmac_f32_32x32x32_bf16 v[68:83], v[44:47], v[132:139], v32
    ds_read_b128 v[44:47], v35 offset:2560
    v_exp_f32 v144, v144
    v_exp_f32 v145, v145
    v_exp_f32 v146, v146
    v_exp_f32 v147, v147
    s_waitcnt lgkmcnt(1)
    v_smfmac_f32_32x32x32_bf16 v[52:67], v[48:51], v[108:115], v32
    v_exp_f32 v84, v84
    v_exp_f32 v85, v85
    v_exp_f32 v86, v86
    v_exp_f32 v87, v87
    v_smfmac_f32_32x32x32_bf16 v[68:83], v[48:51], v[140:147], v32
    ds_read_b128 v[48:51], v35 offset:3200
    v_exp_f32 v88, v88
    v_exp_f32 v89, v89
    v_exp_f32 v90, v90
    v_exp_f32 v91, v91
    v_mfma_f32_32x32x16_bf16 v[100:115], v[36:39], v[16:19], 0
    v_exp_f32 v92, v92
    v_exp_f32 v93, v93
    v_exp_f32 v94, v94
    v_exp_f32 v95, v95
    v_mfma_f32_32x32x16_bf16 v[132:147], v[36:39], v[24:27], 0
    ds_read_b128 v[36:39], v33 offset:4096
    v_exp_f32 v96, v96
    v_exp_f32 v97, v97
    v_exp_f32 v98, v98
    v_exp_f32 v99, v99
    v_mfma_f32_32x32x8_bf16 v[100:115], v[42:43], v[22:23], v[100:115]
    v_exp_f32 v116, v116
    v_exp_f32 v117, v117
    v_exp_f32 v118, v118
    v_exp_f32 v119, v119
    v_mfma_f32_32x32x8_bf16 v[132:147], v[42:43], v[30:31], v[132:147]
    ds_read_b128 v[40:43], v34 offset:512
    v_exp_f32 v120, v120
    v_exp_f32 v121, v121
    v_exp_f32 v122, v122
    v_exp_f32 v123, v123
    s_waitcnt lgkmcnt(3)
    v_smfmac_f32_32x32x32_bf16 v[52:67], v[44:47], v[84:91], v32
    v_exp_f32 v124, v124
    v_exp_f32 v125, v125
    v_exp_f32 v126, v126
    v_exp_f32 v127, v127
    v_smfmac_f32_32x32x32_bf16 v[68:83], v[44:47], v[116:123], v32
    ds_read_b128 v[44:47], v35 offset:3840
    v_exp_f32 v128, v128
    v_exp_f32 v129, v129
    v_exp_f32 v130, v130
    v_exp_f32 v131, v131
    s_waitcnt lgkmcnt(1)
    v_smfmac_f32_32x32x32_bf16 v[52:67], v[48:51], v[92:99], v32
    v_exp_f32 v100, v100
    v_exp_f32 v101, v101
    v_exp_f32 v102, v102
    v_exp_f32 v103, v103
    v_smfmac_f32_32x32x32_bf16 v[68:83], v[48:51], v[124:131], v32
    ds_read_b128 v[48:51], v35 offset:4480
    v_exp_f32 v104, v104
    v_exp_f32 v105, v105
    v_exp_f32 v106, v106
    v_exp_f32 v107, v107
    v_mfma_f32_32x32x16_bf16 v[84:99], v[36:39], v[16:19], 0
    v_exp_f32 v108, v108
    v_exp_f32 v109, v109
    v_exp_f32 v110, v110
    v_exp_f32 v111, v111
    v_mfma_f32_32x32x16_bf16 v[116:131], v[36:39], v[24:27], 0
    ds_read_b128 v[36:39], v33 offset:5120
    v_exp_f32 v112, v112
    v_exp_f32 v113, v113
    v_exp_f32 v114, v114
    v_exp_f32 v115, v115
    v_mfma_f32_32x32x8_bf16 v[84:99], v[40:41], v[20:21], v[84:99]
    v_exp_f32 v132, v132
    v_exp_f32 v133, v133
    v_exp_f32 v134, v134
    v_exp_f32 v135, v135
    v_mfma_f32_32x32x8_bf16 v[116:131], v[40:41], v[28:29], v[116:131]
    v_exp_f32 v136, v136
    v_exp_f32 v137, v137
    v_exp_f32 v138, v138
    v_exp_f32 v139, v139
    s_waitcnt lgkmcnt(2)
    v_smfmac_f32_32x32x32_bf16 v[52:67], v[44:47], v[100:107], v32
    v_exp_f32 v140, v140
    v_exp_f32 v141, v141
    v_exp_f32 v142, v142
    v_exp_f32 v143, v143
    v_smfmac_f32_32x32x32_bf16 v[68:83], v[44:47], v[132:139], v32
    ds_read_b128 v[44:47], v35 offset:5120
    v_exp_f32 v144, v144
    v_exp_f32 v145, v145
    v_exp_f32 v146, v146
    v_exp_f32 v147, v147
    s_waitcnt lgkmcnt(1)
    v_smfmac_f32_32x32x32_bf16 v[52:67], v[48:51], v[108:115], v32
    v_exp_f32 v84, v84
    v_exp_f32 v85, v85
    v_exp_f32 v86, v86
    v_exp_f32 v87, v87
    v_smfmac_f32_32x32x32_bf16 v[68:83], v[48:51], v[140:147], v32
    ds_read_b128 v[48:51], v35 offset:5760
    v_exp_f32 v88, v88
    v_exp_f32 v89, v89
    v_exp_f32 v90, v90
    v_exp_f32 v91, v91
    v_mfma_f32_32x32x16_bf16 v[100:115], v[36:39], v[16:19], 0
    v_exp_f32 v92, v92
    v_exp_f32 v93, v93
    v_exp_f32 v94, v94
    v_exp_f32 v95, v95
    v_mfma_f32_32x32x16_bf16 v[132:147], v[36:39], v[24:27], 0
    ds_read_b128 v[36:39], v33 offset:6144
    v_exp_f32 v96, v96
    v_exp_f32 v97, v97
    v_exp_f32 v98, v98
    v_exp_f32 v99, v99
    v_mfma_f32_32x32x8_bf16 v[100:115], v[40:41], v[22:23], v[100:115]
    v_exp_f32 v116, v116
    v_exp_f32 v117, v117
    v_exp_f32 v118, v118
    v_exp_f32 v119, v119
    v_mfma_f32_32x32x8_bf16 v[132:147], v[40:41], v[30:31], v[132:147]
    v_exp_f32 v120, v120
    v_exp_f32 v121, v121
    v_exp_f32 v122, v122
    v_exp_f32 v123, v123
    s_waitcnt lgkmcnt(2)
    v_smfmac_f32_32x32x32_bf16 v[52:67], v[44:47], v[84:91], v32
    v_exp_f32 v124, v124
    v_exp_f32 v125, v125
    v_exp_f32 v126, v126
    v_exp_f32 v127, v127
    v_smfmac_f32_32x32x32_bf16 v[68:83], v[44:47], v[116:123], v32
    ds_read_b128 v[44:47], v35 offset:6400
    v_exp_f32 v128, v128
    v_exp_f32 v129, v129
    v_exp_f32 v130, v130
    v_exp_f32 v131, v131
    s_waitcnt lgkmcnt(1)
    v_smfmac_f32_32x32x32_bf16 v[52:67], v[48:51], v[92:99], v32
    v_exp_f32 v100, v100
    v_exp_f32 v101, v101
    v_exp_f32 v102, v102
    v_exp_f32 v103, v103
    v_smfmac_f32_32x32x32_bf16 v[68:83], v[48:51], v[124:131], v32
    ds_read_b128 v[48:51], v35 offset:7040
    v_exp_f32 v104, v104
    v_exp_f32 v105, v105
    v_exp_f32 v106, v106
    v_exp_f32 v107, v107
    v_mfma_f32_32x32x16_bf16 v[84:99], v[36:39], v[16:19], 0
    v_exp_f32 v108, v108
    v_exp_f32 v109, v109
    v_exp_f32 v110, v110
    v_exp_f32 v111, v111
    v_mfma_f32_32x32x16_bf16 v[116:131], v[36:39], v[24:27], 0
    ds_read_b128 v[36:39], v33 offset:7168
    v_exp_f32 v112, v112
    v_exp_f32 v113, v113
    v_exp_f32 v114, v114
    v_exp_f32 v115, v115
    v_mfma_f32_32x32x8_bf16 v[84:99], v[42:43], v[20:21], v[84:99]
    v_exp_f32 v132, v132
    v_exp_f32 v133, v133
    v_exp_f32 v134, v134
    v_exp_f32 v135, v135
    v_mfma_f32_32x32x8_bf16 v[116:131], v[42:43], v[28:29], v[116:131]
    v_exp_f32 v136, v136
    v_exp_f32 v137, v137
    v_exp_f32 v138, v138
    v_exp_f32 v139, v139
    s_waitcnt lgkmcnt(2)
    v_smfmac_f32_32x32x32_bf16 v[52:67], v[44:47], v[100:107], v32
    v_exp_f32 v140, v140
    v_exp_f32 v141, v141
    v_exp_f32 v142, v142
    v_exp_f32 v143, v143
    v_smfmac_f32_32x32x32_bf16 v[68:83], v[44:47], v[132:139], v32
    ds_read_b128 v[44:47], v35 offset:7680
    v_exp_f32 v144, v144
    v_exp_f32 v145, v145
    v_exp_f32 v146, v146
    v_exp_f32 v147, v147
    s_waitcnt lgkmcnt(1)
    v_smfmac_f32_32x32x32_bf16 v[52:67], v[48:51], v[108:115], v32
    v_exp_f32 v84, v84
    v_exp_f32 v85, v85
    v_exp_f32 v86, v86
    v_exp_f32 v87, v87
    v_smfmac_f32_32x32x32_bf16 v[68:83], v[48:51], v[140:147], v32
    ds_read_b128 v[48:51], v35 offset:8320
    v_exp_f32 v88, v88
    v_exp_f32 v89, v89
    v_exp_f32 v90, v90
    v_exp_f32 v91, v91
    v_mfma_f32_32x32x16_bf16 v[100:115], v[36:39], v[16:19], 0
    v_exp_f32 v92, v92
    v_exp_f32 v93, v93
    v_exp_f32 v94, v94
    v_exp_f32 v95, v95
    v_mfma_f32_32x32x16_bf16 v[132:147], v[36:39], v[24:27], 0
    ds_read_b128 v[36:39], v33 offset:8192
    v_exp_f32 v96, v96
    v_exp_f32 v97, v97
    v_exp_f32 v98, v98
    v_exp_f32 v99, v99
    v_mfma_f32_32x32x8_bf16 v[100:115], v[42:43], v[22:23], v[100:115]
    v_exp_f32 v116, v116
    v_exp_f32 v117, v117
    v_exp_f32 v118, v118
    v_exp_f32 v119, v119
    v_mfma_f32_32x32x8_bf16 v[132:147], v[42:43], v[30:31], v[132:147]
    ds_read_b128 v[40:43], v34 offset:1024
    v_exp_f32 v120, v120
    v_exp_f32 v121, v121
    v_exp_f32 v122, v122
    v_exp_f32 v123, v123
    s_waitcnt lgkmcnt(3)
    v_smfmac_f32_32x32x32_bf16 v[52:67], v[44:47], v[84:91], v32
    v_exp_f32 v124, v124
    v_exp_f32 v125, v125
    v_exp_f32 v126, v126
    v_exp_f32 v127, v127
    v_smfmac_f32_32x32x32_bf16 v[68:83], v[44:47], v[116:123], v32
    ds_read_b128 v[44:47], v35 offset:8960
    v_exp_f32 v128, v128
    v_exp_f32 v129, v129
    v_exp_f32 v130, v130
    v_exp_f32 v131, v131
    s_waitcnt lgkmcnt(1)
    v_smfmac_f32_32x32x32_bf16 v[52:67], v[48:51], v[92:99], v32
    v_exp_f32 v100, v100
    v_exp_f32 v101, v101
    v_exp_f32 v102, v102
    v_exp_f32 v103, v103
    v_smfmac_f32_32x32x32_bf16 v[68:83], v[48:51], v[124:131], v32
    ds_read_b128 v[48:51], v35 offset:9600
    v_exp_f32 v104, v104
    v_exp_f32 v105, v105
    v_exp_f32 v106, v106
    v_exp_f32 v107, v107
    v_mfma_f32_32x32x16_bf16 v[84:99], v[36:39], v[16:19], 0
    v_exp_f32 v108, v108
    v_exp_f32 v109, v109
    v_exp_f32 v110, v110
    v_exp_f32 v111, v111
    v_mfma_f32_32x32x16_bf16 v[116:131], v[36:39], v[24:27], 0
    ds_read_b128 v[36:39], v33 offset:9216
    v_exp_f32 v112, v112
    v_exp_f32 v113, v113
    v_exp_f32 v114, v114
    v_exp_f32 v115, v115
    v_mfma_f32_32x32x8_bf16 v[84:99], v[40:41], v[20:21], v[84:99]
    v_exp_f32 v132, v132
    v_exp_f32 v133, v133
    v_exp_f32 v134, v134
    v_exp_f32 v135, v135
    v_mfma_f32_32x32x8_bf16 v[116:131], v[40:41], v[28:29], v[116:131]
    v_exp_f32 v136, v136
    v_exp_f32 v137, v137
    v_exp_f32 v138, v138
    v_exp_f32 v139, v139
    s_waitcnt lgkmcnt(2)
    v_smfmac_f32_32x32x32_bf16 v[52:67], v[44:47], v[100:107], v32
    v_exp_f32 v140, v140
    v_exp_f32 v141, v141
    v_exp_f32 v142, v142
    v_exp_f32 v143, v143
    v_smfmac_f32_32x32x32_bf16 v[68:83], v[44:47], v[132:139], v32
    ds_read_b128 v[44:47], v35 offset:10240
    v_exp_f32 v144, v144
    v_exp_f32 v145, v145
    v_exp_f32 v146, v146
    v_exp_f32 v147, v147
    v_add_u32 v33, 8192, v33
    v_add_u32 v34, 1024, v34
    v_add_u32 v35, 10240, v35
    s_waitcnt lgkmcnt(1)
    s_cmp_eq_u32 s48, 0
    s_cbranch_scc1 L_p0_62
    s_setprio 1
    s_branch L_p1_63
L_p0_62:
    s_setprio 0
L_p1_63:
    s_nop 3
    v_smfmac_f32_32x32x32_bf16 v[52:67], v[48:51], v[108:115], v32
    v_exp_f32 v84, v84
    v_exp_f32 v85, v85
    v_exp_f32 v86, v86
    v_exp_f32 v87, v87
    v_smfmac_f32_32x32x32_bf16 v[68:83], v[48:51], v[140:147], v32
    ds_read_b128 v[48:51], v35 offset:640
    v_exp_f32 v88, v88
    v_exp_f32 v89, v89
    v_exp_f32 v90, v90
    v_exp_f32 v91, v91
    v_mfma_f32_32x32x16_bf16 v[100:115], v[36:39], v[16:19], 0
    v_exp_f32 v92, v92
    v_exp_f32 v93, v93
    v_exp_f32 v94, v94
    v_exp_f32 v95, v95
    v_mfma_f32_32x32x16_bf16 v[132:147], v[36:39], v[24:27], 0
    ds_read_b128 v[36:39], v33 offset:2048
    v_exp_f32 v96, v96
    v_exp_f32 v97, v97
    v_exp_f32 v98, v98
    v_exp_f32 v99, v99
    v_mfma_f32_32x32x8_bf16 v[100:115], v[40:41], v[22:23], v[100:115]
    v_exp_f32 v116, v116
    v_exp_f32 v117, v117
    v_exp_f32 v118, v118
    v_exp_f32 v119, v119
    v_mfma_f32_32x32x8_bf16 v[132:147], v[40:41], v[30:31], v[132:147]
    v_exp_f32 v120, v120
    v_exp_f32 v121, v121
    v_exp_f32 v122, v122
    v_exp_f32 v123, v123
    s_waitcnt lgkmcnt(2)
    v_smfmac_f32_32x32x32_bf16 v[52:67], v[44:47], v[84:91], v32
    v_exp_f32 v124, v124
    v_exp_f32 v125, v125
    v_exp_f32 v126, v126
    v_exp_f32 v127, v127
    v_smfmac_f32_32x32x32_bf16 v[68:83], v[44:47], v[116:123], v32
    ds_read_b128 v[44:47], v35 offset:1280
    v_exp_f32 v128, v128
    v_exp_f32 v129, v129
    v_exp_f32 v130, v130
    v_exp_f32 v131, v131
    s_waitcnt lgkmcnt(1)
    v_smfmac_f32_32x32x32_bf16 v[52:67], v[48:51], v[92:99], v32
    v_exp_f32 v100, v100
    v_exp_f32 v101, v101
    v_exp_f32 v102, v102
    v_exp_f32 v103, v103
    v_smfmac_f32_32x32x32_bf16 v[68:83], v[48:51], v[124:131], v32
    ds_read_b128 v[48:51], v35 offset:1920
    v_exp_f32 v104, v104
    v_exp_f32 v105, v105
    v_exp_f32 v106, v106
    v_exp_f32 v107, v107
    v_mfma_f32_32x32x16_bf16 v[84:99], v[36:39], v[16:19], 0
    v_exp_f32 v108, v108
    v_exp_f32 v109, v109
    v_exp_f32 v110, v110
    v_exp_f32 v111, v111
    v_mfma_f32_32x32x16_bf16 v[116:131], v[36:39], v[24:27], 0
    ds_read_b128 v[36:39], v33 offset:3072
    v_exp_f32 v112, v112
    v_exp_f32 v113, v113
    v_exp_f32 v114, v114
    v_exp_f32 v115, v115
    v_mfma_f32_32x32x8_bf16 v[84:99], v[42:43], v[20:21], v[84:99]
    v_exp_f32 v132, v132
    v_exp_f32 v133, v133
    v_exp_f32 v134, v134
    v_exp_f32 v135, v135
    v_mfma_f32_32x32x8_bf16 v[116:131], v[42:43], v[28:29], v[116:131]
    v_exp_f32 v136, v136
    v_exp_f32 v137, v137
    v_exp_f32 v138, v138
    v_exp_f32 v139, v139
    s_waitcnt lgkmcnt(2)
    v_smfmac_f32_32x32x32_bf16 v[52:67], v[44:47], v[100:107], v32
    v_exp_f32 v140, v140
    v_exp_f32 v141, v141
    v_exp_f32 v142, v142
    v_exp_f32 v143, v143
    v_smfmac_f32_32x32x32_bf16 v[68:83], v[44:47], v[132:139], v32
    ds_read_b128 v[44:47], v35 offset:2560
    v_exp_f32 v144, v144
    v_exp_f32 v145, v145
    v_exp_f32 v146, v146
    v_exp_f32 v147, v147
    s_waitcnt lgkmcnt(1)
    v_smfmac_f32_32x32x32_bf16 v[52:67], v[48:51], v[108:115], v32
    v_exp_f32 v84, v84
    v_exp_f32 v85, v85
    v_exp_f32 v86, v86
    v_exp_f32 v87, v87
    v_smfmac_f32_32x32x32_bf16 v[68:83], v[48:51], v[140:147], v32
    ds_read_b128 v[48:51], v35 offset:3200
    v_exp_f32 v88, v88
    v_exp_f32 v89, v89
    v_exp_f32 v90, v90
    v_exp_f32 v91, v91
    v_mfma_f32_32x32x16_bf16 v[100:115], v[36:39], v[16:19], 0
    v_exp_f32 v92, v92
    v_exp_f32 v93, v93
    v_exp_f32 v94, v94
    v_exp_f32 v95, v95
    v_mfma_f32_32x32x16_bf16 v[132:147], v[36:39], v[24:27], 0
    ds_read_b128 v[36:39], v33 offset:4096
    v_exp_f32 v96, v96
    v_exp_f32 v97, v97
    v_exp_f32 v98, v98
    v_exp_f32 v99, v99
    v_mfma_f32_32x32x8_bf16 v[100:115], v[42:43], v[22:23], v[100:115]
    v_exp_f32 v116, v116
    v_exp_f32 v117, v117
    v_exp_f32 v118, v118
    v_exp_f32 v119, v119
    v_mfma_f32_32x32x8_bf16 v[132:147], v[42:43], v[30:31], v[132:147]
    ds_read_b128 v[40:43], v34 offset:512
    v_exp_f32 v120, v120
    v_exp_f32 v121, v121
    v_exp_f32 v122, v122
    v_exp_f32 v123, v123
    s_waitcnt lgkmcnt(3)
    v_smfmac_f32_32x32x32_bf16 v[52:67], v[44:47], v[84:91], v32
    v_exp_f32 v124, v124
    v_exp_f32 v125, v125
    v_exp_f32 v126, v126
    v_exp_f32 v127, v127
    v_smfmac_f32_32x32x32_bf16 v[68:83], v[44:47], v[116:123], v32
    ds_read_b128 v[44:47], v35 offset:3840
    v_exp_f32 v128, v128
    v_exp_f32 v129, v129
    v_exp_f32 v130, v130
    v_exp_f32 v131, v131
    s_waitcnt lgkmcnt(1)
    v_smfmac_f32_32x32x32_bf16 v[52:67], v[48:51], v[92:99], v32
    v_exp_f32 v100, v100
    v_exp_f32 v101, v101
    v_exp_f32 v102, v102
    v_exp_f32 v103, v103
    v_smfmac_f32_32x32x32_bf16 v[68:83], v[48:51], v[124:131], v32
    ds_read_b128 v[48:51], v35 offset:4480
    v_exp_f32 v104, v104
    v_exp_f32 v105, v105
    v_exp_f32 v106, v106
    v_exp_f32 v107, v107
    v_mfma_f32_32x32x16_bf16 v[84:99], v[36:39], v[16:19], 0
    v_exp_f32 v108, v108
    v_exp_f32 v109, v109
    v_exp_f32 v110, v110
    v_exp_f32 v111, v111
    v_mfma_f32_32x32x16_bf16 v[116:131], v[36:39], v[24:27], 0
    ds_read_b128 v[36:39], v33 offset:5120
    v_exp_f32 v112, v112
    v_exp_f32 v113, v113
    v_exp_f32 v114, v114
    v_exp_f32 v115, v115
    v_mfma_f32_32x32x8_bf16 v[84:99], v[40:41], v[20:21], v[84:99]
    v_exp_f32 v132, v132
    v_exp_f32 v133, v133
    v_exp_f32 v134, v134
    v_exp_f32 v135, v135
    v_mfma_f32_32x32x8_bf16 v[116:131], v[40:41], v[28:29], v[116:131]
    v_exp_f32 v136, v136
    v_exp_f32 v137, v137
    v_exp_f32 v138, v138
    v_exp_f32 v139, v139
    s_waitcnt lgkmcnt(2)
    v_smfmac_f32_32x32x32_bf16 v[52:67], v[44:47], v[100:107], v32
    v_exp_f32 v140, v140
    v_exp_f32 v141, v141
    v_exp_f32 v142, v142
    v_exp_f32 v143, v143
    v_smfmac_f32_32x32x32_bf16 v[68:83], v[44:47], v[132:139], v32
    ds_read_b128 v[44:47], v35 offset:5120
    v_exp_f32 v144, v144
    v_exp_f32 v145, v145
    v_exp_f32 v146, v146
    v_exp_f32 v147, v147
    s_waitcnt lgkmcnt(1)
    v_smfmac_f32_32x32x32_bf16 v[52:67], v[48:51], v[108:115], v32
    v_exp_f32 v84, v84
    v_exp_f32 v85, v85
    v_exp_f32 v86, v86
    v_exp_f32 v87, v87
    v_smfmac_f32_32x32x32_bf16 v[68:83], v[48:51], v[140:147], v32
    ds_read_b128 v[48:51], v35 offset:5760
    v_exp_f32 v88, v88
    v_exp_f32 v89, v89
    v_exp_f32 v90, v90
    v_exp_f32 v91, v91
    v_mfma_f32_32x32x16_bf16 v[100:115], v[36:39], v[16:19], 0
    v_exp_f32 v92, v92
    v_exp_f32 v93, v93
    v_exp_f32 v94, v94
    v_exp_f32 v95, v95
    v_mfma_f32_32x32x16_bf16 v[132:147], v[36:39], v[24:27], 0
    ds_read_b128 v[36:39], v33 offset:6144
    v_exp_f32 v96, v96
    v_exp_f32 v97, v97
    v_exp_f32 v98, v98
    v_exp_f32 v99, v99
    v_mfma_f32_32x32x8_bf16 v[100:115], v[40:41], v[22:23], v[100:115]
    v_exp_f32 v116, v116
    v_exp_f32 v117, v117
    v_exp_f32 v118, v118
    v_exp_f32 v119, v119
    v_mfma_f32_32x32x8_bf16 v[132:147], v[40:41], v[30:31], v[132:147]
    v_exp_f32 v120, v120
    v_exp_f32 v121, v121
    v_exp_f32 v122, v122
    v_exp_f32 v123, v123
    s_waitcnt lgkmcnt(2)
    v_smfmac_f32_32x32x32_bf16 v[52:67], v[44:47], v[84:91], v32
    v_exp_f32 v124, v124
    v_exp_f32 v125, v125
    v_exp_f32 v126, v126
    v_exp_f32 v127, v127
    v_smfmac_f32_32x32x32_bf16 v[68:83], v[44:47], v[116:123], v32
    ds_read_b128 v[44:47], v35 offset:6400
    v_exp_f32 v128, v128
    v_exp_f32 v129, v129
    v_exp_f32 v130, v130
    v_exp_f32 v131, v131
    s_waitcnt lgkmcnt(1)
    v_smfmac_f32_32x32x32_bf16 v[52:67], v[48:51], v[92:99], v32
    v_exp_f32 v100, v100
    v_exp_f32 v101, v101
    v_exp_f32 v102, v102
    v_exp_f32 v103, v103
    v_smfmac_f32_32x32x32_bf16 v[68:83], v[48:51], v[124:131], v32
    ds_read_b128 v[48:51], v35 offset:7040
    v_exp_f32 v104, v104
    v_exp_f32 v105, v105
    v_exp_f32 v106, v106
    v_exp_f32 v107, v107
    v_mfma_f32_32x32x16_bf16 v[84:99], v[36:39], v[16:19], 0
    v_exp_f32 v108, v108
    v_exp_f32 v109, v109
    v_exp_f32 v110, v110
    v_exp_f32 v111, v111
    v_mfma_f32_32x32x16_bf16 v[116:131], v[36:39], v[24:27], 0
    ds_read_b128 v[36:39], v33 offset:7168
    v_exp_f32 v112, v112
    v_exp_f32 v113, v113
    v_exp_f32 v114, v114
    v_exp_f32 v115, v115
    v_mfma_f32_32x32x8_bf16 v[84:99], v[42:43], v[20:21], v[84:99]
    v_exp_f32 v132, v132
    v_exp_f32 v133, v133
    v_exp_f32 v134, v134
    v_exp_f32 v135, v135
    v_mfma_f32_32x32x8_bf16 v[116:131], v[42:43], v[28:29], v[116:131]
    v_exp_f32 v136, v136
    v_exp_f32 v137, v137
    v_exp_f32 v138, v138
    v_exp_f32 v139, v139
    s_waitcnt lgkmcnt(2)
    v_smfmac_f32_32x32x32_bf16 v[52:67], v[44:47], v[100:107], v32
    v_exp_f32 v140, v140
    v_exp_f32 v141, v141
    v_exp_f32 v142, v142
    v_exp_f32 v143, v143
    v_smfmac_f32_32x32x32_bf16 v[68:83], v[44:47], v[132:139], v32
    ds_read_b128 v[44:47], v35 offset:7680
    v_exp_f32 v144, v144
    v_exp_f32 v145, v145
    v_exp_f32 v146, v146
    v_exp_f32 v147, v147
    s_waitcnt lgkmcnt(1)
    v_smfmac_f32_32x32x32_bf16 v[52:67], v[48:51], v[108:115], v32
    v_exp_f32 v84, v84
    v_exp_f32 v85, v85
    v_exp_f32 v86, v86
    v_exp_f32 v87, v87
    v_smfmac_f32_32x32x32_bf16 v[68:83], v[48:51], v[140:147], v32
    ds_read_b128 v[48:51], v35 offset:8320
    v_exp_f32 v88, v88
    v_exp_f32 v89, v89
    v_exp_f32 v90, v90
    v_exp_f32 v91, v91
    v_mfma_f32_32x32x16_bf16 v[100:115], v[36:39], v[16:19], 0
    v_exp_f32 v92, v92
    v_exp_f32 v93, v93
    v_exp_f32 v94, v94
    v_exp_f32 v95, v95
    v_mfma_f32_32x32x16_bf16 v[132:147], v[36:39], v[24:27], 0
    ds_read_b128 v[36:39], v33 offset:8192
    v_exp_f32 v96, v96
    v_exp_f32 v97, v97
    v_exp_f32 v98, v98
    v_exp_f32 v99, v99
    v_mfma_f32_32x32x8_bf16 v[100:115], v[42:43], v[22:23], v[100:115]
    v_exp_f32 v116, v116
    v_exp_f32 v117, v117
    v_exp_f32 v118, v118
    v_exp_f32 v119, v119
    v_mfma_f32_32x32x8_bf16 v[132:147], v[42:43], v[30:31], v[132:147]
    ds_read_b128 v[40:43], v34 offset:1024
    v_exp_f32 v120, v120
    v_exp_f32 v121, v121
    v_exp_f32 v122, v122
    v_exp_f32 v123, v123
    s_waitcnt lgkmcnt(3)
    v_smfmac_f32_32x32x32_bf16 v[52:67], v[44:47], v[84:91], v32
    v_exp_f32 v124, v124
    v_exp_f32 v125, v125
    v_exp_f32 v126, v126
    v_exp_f32 v127, v127
    v_smfmac_f32_32x32x32_bf16 v[68:83], v[44:47], v[116:123], v32
    ds_read_b128 v[44:47], v35 offset:8960
    v_exp_f32 v128, v128
    v_exp_f32 v129, v129
    v_exp_f32 v130, v130
    v_exp_f32 v131, v131
    s_waitcnt lgkmcnt(1)
    v_smfmac_f32_32x32x32_bf16 v[52:67], v[48:51], v[92:99], v32
    v_exp_f32 v100, v100
    v_exp_f32 v101, v101
    v_exp_f32 v102, v102
    v_exp_f32 v103, v103
    v_smfmac_f32_32x32x32_bf16 v[68:83], v[48:51], v[124:131], v32
    ds_read_b128 v[48:51], v35 offset:9600
    v_exp_f32 v104, v104
    v_exp_f32 v105, v105
    v_exp_f32 v106, v106
    v_exp_f32 v107, v107
    v_mfma_f32_32x32x16_bf16 v[84:99], v[36:39], v[16:19], 0
    v_exp_f32 v108, v108
    v_exp_f32 v109, v109
    v_exp_f32 v110, v110
    v_exp_f32 v111, v111
    v_mfma_f32_32x32x16_bf16 v[116:131], v[36:39], v[24:27], 0
    ds_read_b128 v[36:39], v33 offset:9216
    v_exp_f32 v112, v112
    v_exp_f32 v113, v113
    v_exp_f32 v114, v114
    v_exp_f32 v115, v115
    v_mfma_f32_32x32x8_bf16 v[84:99], v[40:41], v[20:21], v[84:99]
    v_exp_f32 v132, v132
    v_exp_f32 v133, v133
    v_exp_f32 v134, v134
    v_exp_f32 v135, v135
    v_mfma_f32_32x32x8_bf16 v[116:131], v[40:41], v[28:29], v[116:131]
    v_exp_f32 v136, v136
    v_exp_f32 v137, v137
    v_exp_f32 v138, v138
    v_exp_f32 v139, v139
    s_waitcnt lgkmcnt(2)
    v_smfmac_f32_32x32x32_bf16 v[52:67], v[44:47], v[100:107], v32
    v_exp_f32 v140, v140
    v_exp_f32 v141, v141
    v_exp_f32 v142, v142
    v_exp_f32 v143, v143
    v_smfmac_f32_32x32x32_bf16 v[68:83], v[44:47], v[132:139], v32
    ds_read_b128 v[44:47], v35 offset:10240
    v_exp_f32 v144, v144
    v_exp_f32 v145, v145
    v_exp_f32 v146, v146
    v_exp_f32 v147, v147
    v_add_u32 v33, 8192, v33
    v_add_u32 v34, 1024, v34
    v_add_u32 v35, 10240, v35
    s_waitcnt lgkmcnt(1)
    s_waitcnt vmcnt(0) lgkmcnt(0)
    s_barrier
    s_and_b32 s90, s84, 1
    s_mul_i32 s90, s90, 18
    s_bfe_u32 s91, s84, 0x10001
    s_lshl2_add_u32 s90, s91, s90
    s_mul_i32 s91, s48, 36
    s_add_u32 s90, s90, s91
    s_mul_i32 s64, s90, 1152
    s_mul_i32 s95, s86, 72
    s_add_u32 s64, s64, s95
    s_mul_i32 s65, s84, 82944
    s_add_u32 s65, s65, s95
    s_add_u32 s65, s65, 18432
    s_mul_i32 s66, s48, 13312
    s_sub_u32 s67, 19456, s66
    s_add_u32 s66, s66, 6144
    s_mul_i32 s91, s84, 768
    s_add_u32 m0, s91, 73728
    s_getpc_b64 s[30:31]
L_pc_64:
    s_add_u32 s30, s30, L_tail_start-L_pc_64
    s_addc_u32 s31, s31, 0
    v_and_b32 v15, 7, v1
    v_lshl_add_u32 v15, s84, 3, v15
    v_lshlrev_b32 v15, 7, v15
    v_min_u32 v15, L_code_end-L_tail_start-4, v15
    s_cmp_eq_u32 s48, 1
    s_cbranch_scc1 L_p0_65
    s_setprio 1
    s_branch L_p1_66
L_p0_65:
    s_setprio 0
L_p1_66:
    s_nop 3
    v_smfmac_f32_32x32x32_bf16 v[52:67], v[48:51], v[108:115], v32
    v_exp_f32 v84, v84
    v_exp_f32 v85, v85
    s_mov_b32 exec_hi, 0xffff
    buffer_load_dwordx4 v244, s[44:47], s64 offen lds
    s_mov_b32 exec_hi, -1
    v_exp_f32 v86, v86
    v_exp_f32 v87, v87
    v_smfmac_f32_32x32x32_bf16 v[68:83], v[48:51], v[140:147], v32
    ds_read_b128 v[48:51], v35 offset:640
    v_exp_f32 v88, v88
    v_exp_f32 v89, v89
    v_exp_f32 v90, v90
    v_exp_f32 v91, v91
    v_mfma_f32_32x32x16_bf16 v[100:115], v[36:39], v[16:19], 0
    v_exp_f32 v92, v92
    v_exp_f32 v93, v93
    s_add_u32 m0, m0, 6144
    v_exp_f32 v94, v94
    v_exp_f32 v95, v95
    v_mfma_f32_32x32x16_bf16 v[132:147], v[36:39], v[24:27], 0
    ds_read_b128 v[36:39], v33 offset:2048
    v_exp_f32 v96, v96
    v_exp_f32 v97, v97
    v_exp_f32 v98, v98
    v_exp_f32 v99, v99
    v_mfma_f32_32x32x8_bf16 v[100:115], v[40:41], v[22:23], v[100:115]
    v_exp_f32 v116, v116
    v_exp_f32 v117, v117
    v_exp_f32 v118, v118
    v_exp_f32 v119, v119
    s_add_u32 s64, s64, 82944
    v_mfma_f32_32x32x8_bf16 v[132:147], v[40:41], v[30:31], v[132:147]
    v_exp_f32 v120, v120
    v_exp_f32 v121, v121
    v_exp_f32 v122, v122
    v_exp_f32 v123, v123
    s_waitcnt lgkmcnt(2)
    v_smfmac_f32_32x32x32_bf16 v[52:67], v[44:47], v[84:91], v32
    v_exp_f32 v124, v124
    v_exp_f32 v125, v125
    v_exp_f32 v126, v126
    v_exp_f32 v127, v127
    s_mov_b32 exec_hi, 0xffff
    buffer_load_dwordx4 v244, s[44:47], s64 offen lds
    s_mov_b32 exec_hi, -1
    v_smfmac_f32_32x32x32_bf16 v[68:83], v[44:47], v[116:123], v32
    ds_read_b128 v[44:47], v35 offset:1280
    v_exp_f32 v128, v128
    v_exp_f32 v129, v129
    v_exp_f32 v130, v130
    v_exp_f32 v131, v131
    s_waitcnt lgkmcnt(1)
    v_smfmac_f32_32x32x32_bf16 v[52:67], v[48:51], v[92:99], v32
    v_exp_f32 v100, v100
    v_exp_f32 v101, v101
    v_exp_f32 v102, v102
    v_exp_f32 v103, v103
    v_smfmac_f32_32x32x32_bf16 v[68:83], v[48:51], v[124:131], v32
    ds_read_b128 v[48:51], v35 offset:1920
    v_exp_f32 v104, v104
    v_exp_f32 v105, v105
    s_add_u32 m0, m0, 6144
    v_exp_f32 v106, v106
    v_exp_f32 v107, v107
    v_mfma_f32_32x32x16_bf16 v[84:99], v[36:39], v[16:19], 0
    v_exp_f32 v108, v108
    v_exp_f32 v109, v109
    v_exp_f32 v110, v110
    v_exp_f32 v111, v111
    v_mfma_f32_32x32x16_bf16 v[116:131], v[36:39], v[24:27], 0
    ds_read_b128 v[36:39], v33 offset:3072
    v_exp_f32 v112, v112
    v_exp_f32 v113, v113
    s_add_u32 s64, s64, 82944
    v_exp_f32 v114, v114
    v_exp_f32 v115, v115
    v_mfma_f32_32x32x8_bf16 v[84:99], v[42:43], v[20:21], v[84:99]
    v_exp_f32 v132, v132
    v_exp_f32 v133, v133
    v_exp_f32 v134, v134
    v_exp_f32 v135, v135
    v_mfma_f32_32x32x8_bf16 v[116:131], v[42:43], v[28:29], v[116:131]
    v_exp_f32 v136, v136
    v_exp_f32 v137, v137
    v_exp_f32 v138, v138
    v_exp_f32 v139, v139
    s_mov_b32 exec_hi, 0xffff
    buffer_load_dwordx4 v244, s[44:47], s64 offen lds
    s_mov_b32 exec_hi, -1
    s_waitcnt lgkmcnt(2)
    v_smfmac_f32_32x32x32_bf16 v[52:67], v[44:47], v[100:107], v32
    v_exp_f32 v140, v140
    v_exp_f32 v141, v141
    v_exp_f32 v142, v142
    v_exp_f32 v143, v143
    v_smfmac_f32_32x32x32_bf16 v[68:83], v[44:47], v[132:139], v32
    ds_read_b128 v[44:47], v35 offset:2560
    v_exp_f32 v144, v144
    v_exp_f32 v145, v145
    v_exp_f32 v146, v146
    v_exp_f32 v147, v147
    s_add_u32 m0, m0, 6144
    s_waitcnt lgkmcnt(1)
    v_smfmac_f32_32x32x32_bf16 v[52:67], v[48:51], v[108:115], v32
    v_exp_f32 v84, v84
    v_exp_f32 v85, v85
    v_exp_f32 v86, v86
    v_exp_f32 v87, v87
    v_smfmac_f32_32x32x32_bf16 v[68:83], v[48:51], v[140:147], v32
    ds_read_b128 v[48:51], v35 offset:3200
    v_exp_f32 v88, v88
    v_exp_f32 v89, v89
    v_exp_f32 v90, v90
    v_exp_f32 v91, v91
    v_mfma_f32_32x32x16_bf16 v[100:115], v[36:39], v[16:19], 0
    v_exp_f32 v92, v92
    v_exp_f32 v93, v93
    s_add_u32 s64, s64, 82944
    v_exp_f32 v94, v94
    v_exp_f32 v95, v95
    v_mfma_f32_32x32x16_bf16 v[132:147], v[36:39], v[24:27], 0
    ds_read_b128 v[36:39], v33 offset:4096
    v_exp_f32 v96, v96
    v_exp_f32 v97, v97
    v_exp_f32 v98, v98
    v_exp_f32 v99, v99
    v_mfma_f32_32x32x8_bf16 v[100:115], v[42:43], v[22:23], v[100:115]
    v_exp_f32 v116, v116
    v_exp_f32 v117, v117
    s_mov_b32 exec_hi, 0xffff
    buffer_load_dwordx4 v244, s[44:47], s64 offen lds
    s_mov_b32 exec_hi, -1
    v_exp_f32 v118, v118
    v_exp_f32 v119, v119
    v_mfma_f32_32x32x8_bf16 v[132:147], v[42:43], v[30:31], v[132:147]
    ds_read_b128 v[40:43], v34 offset:512
    v_exp_f32 v120, v120
    v_exp_f32 v121, v121
    v_exp_f32 v122, v122
    v_exp_f32 v123, v123
    s_waitcnt lgkmcnt(3)
    v_smfmac_f32_32x32x32_bf16 v[52:67], v[44:47], v[84:91], v32
    v_exp_f32 v124, v124
    v_exp_f32 v125, v125
    v_exp_f32 v126, v126
    v_exp_f32 v127, v127
    s_add_u32 m0, m0, s66
    v_smfmac_f32_32x32x32_bf16 v[68:83], v[44:47], v[116:123], v32
    ds_read_b128 v[44:47], v35 offset:3840
    v_exp_f32 v128, v128
    v_exp_f32 v129, v129
    v_exp_f32 v130, v130
    v_exp_f32 v131, v131
    s_waitcnt lgkmcnt(1)
    v_smfmac_f32_32x32x32_bf16 v[52:67], v[48:51], v[92:99], v32
    v_exp_f32 v100, v100
    v_exp_f32 v101, v101
    v_exp_f32 v102, v102
    v_exp_f32 v103, v103
    s_add_u32 s64, s64, 82944
    v_smfmac_f32_32x32x32_bf16 v[68:83], v[48:51], v[124:131], v32
    ds_read_b128 v[48:51], v35 offset:4480
    v_exp_f32 v104, v104
    v_exp_f32 v105, v105
    v_exp_f32 v106, v106
    v_exp_f32 v107, v107
    v_mfma_f32_32x32x16_bf16 v[84:99], v[36:39], v[16:19], 0
    v_exp_f32 v108, v108
    v_exp_f32 v109, v109
    v_exp_f32 v110, v110
    v_exp_f32 v111, v111
    v_mfma_f32_32x32x16_bf16 v[116:131], v[36:39], v[24:27], 0
    ds_read_b128 v[36:39], v33 offset:5120
    v_exp_f32 v112, v112
    v_exp_f32 v113, v113
    s_mov_b32 exec_hi, 0xffff
    buffer_load_dwordx4 v244, s[44:47], s64 offen lds
    s_mov_b32 exec_hi, -1
    v_exp_f32 v114, v114
    v_exp_f32 v115, v115
    v_mfma_f32_32x32x8_bf16 v[84:99], v[40:41], v[20:21], v[84:99]
    v_exp_f32 v132, v132
    v_exp_f32 v133, v133
    v_exp_f32 v134, v134
    v_exp_f32 v135, v135
    v_mfma_f32_32x32x8_bf16 v[116:131], v[40:41], v[28:29], v[116:131]
    v_exp_f32 v136, v136
    v_exp_f32 v137, v137
    v_exp_f32 v138, v138
    v_exp_f32 v139, v139
    s_add_u32 m0, m0, s67
    s_waitcnt lgkmcnt(2)
    v_smfmac_f32_32x32x32_bf16 v[52:67], v[44:47], v[100:107], v32
    v_exp_f32 v140, v140
    v_exp_f32 v141, v141
    global_load_dword v239, v15, s[30:31]
    v_exp_f32 v142, v142
    v_exp_f32 v143, v143
    v_smfmac_f32_32x32x32_bf16 v[68:83], v[44:47], v[132:139], v32
    ds_read_b128 v[44:47], v35 offset:5120
    v_exp_f32 v144, v144
    v_exp_f32 v145, v145
    v_exp_f32 v146, v146
    v_exp_f32 v147, v147
    s_add_u32 s64, s64, 82944
    s_waitcnt lgkmcnt(1)
    v_smfmac_f32_32x32x32_bf16 v[52:67], v[48:51], v[108:115], v32
    v_exp_f32 v84, v84
    v_exp_f32 v85, v85
    v_exp_f32 v86, v86
    v_exp_f32 v87, v87
    v_smfmac_f32_32x32x32_bf16 v[68:83], v[48:51], v[140:147], v32
    ds_read_b128 v[48:51], v35 offset:5760
    v_exp_f32 v88, v88
    v_exp_f32 v89, v89
    v_exp_f32 v90, v90
    v_exp_f32 v91, v91
    v_mfma_f32_32x32x16_bf16 v[100:115], v[36:39], v[16:19], 0
    v_exp_f32 v92, v92
    v_exp_f32 v93, v93
    s_mov_b32 exec_hi, 0xffff
    buffer_load_dwordx4 v244, s[44:47], s64 offen lds
    s_mov_b32 exec_hi, -1
    v_exp_f32 v94, v94
    v_exp_f32 v95, v95
    v_mfma_f32_32x32x16_bf16 v[132:147], v[36:39], v[24:27], 0
    ds_read_b128 v[36:39], v33 offset:6144
    v_exp_f32 v96, v96
    v_exp_f32 v97, v97
    v_exp_f32 v98, v98
    v_exp_f32 v99, v99
    v_mfma_f32_32x32x8_bf16 v[100:115], v[40:41], v[22:23], v[100:115]
    v_exp_f32 v116, v116
    v_exp_f32 v117, v117
    s_add_u32 m0, m0, 6144
    v_exp_f32 v118, v118
    v_exp_f32 v119, v119
    v_mfma_f32_32x32x8_bf16 v[132:147], v[40:41], v[30:31], v[132:147]
    v_exp_f32 v120, v120
    v_exp_f32 v121, v121
    v_exp_f32 v122, v122
    v_exp_f32 v123, v123
    s_waitcnt lgkmcnt(2)
    v_smfmac_f32_32x32x32_bf16 v[52:67], v[44:47], v[84:91], v32
    v_exp_f32 v124, v124
    v_exp_f32 v125, v125
    v_exp_f32 v126, v126
    v_exp_f32 v127, v127
    s_add_u32 s64, s64, 82944
    v_smfmac_f32_32x32x32_bf16 v[68:83], v[44:47], v[116:123], v32
    ds_read_b128 v[44:47], v35 offset:6400
    v_exp_f32 v128, v128
    v_exp_f32 v129, v129
    v_exp_f32 v130, v130
    v_exp_f32 v131, v131
    s_waitcnt lgkmcnt(1)
    v_smfmac_f32_32x32x32_bf16 v[52:67], v[48:51], v[92:99], v32
    v_exp_f32 v100, v100
    v_exp_f32 v101, v101
    v_exp_f32 v102, v102
    v_exp_f32 v103, v103
    s_mov_b32 exec_hi, 0xffff
    buffer_load_dwordx4 v244, s[44:47], s64 offen lds
    s_mov_b32 exec_hi, -1
    v_smfmac_f32_32x32x32_bf16 v[68:83], v[48:51], v[124:131], v32
    ds_read_b128 v[48:51], v35 offset:7040
    v_exp_f32 v104, v104
    v_exp_f32 v105, v105
    v_exp_f32 v106, v106
    v_exp_f32 v107, v107
    v_mfma_f32_32x32x16_bf16 v[84:99], v[36:39], v[16:19], 0
    v_exp_f32 v108, v108
    v_exp_f32 v109, v109
    v_exp_f32 v110, v110
    v_exp_f32 v111, v111
    v_mfma_f32_32x32x16_bf16 v[116:131], v[36:39], v[24:27], 0
    ds_read_b128 v[36:39], v33 offset:7168
    v_exp_f32 v112, v112
    v_exp_f32 v113, v113
    s_add_u32 m0, m0, 6144
    v_exp_f32 v114, v114
    v_exp_f32 v115, v115
    v_mfma_f32_32x32x8_bf16 v[84:99], v[42:43], v[20:21], v[84:99]
    v_exp_f32 v132, v132
    v_exp_f32 v133, v133
    v_exp_f32 v134, v134
    v_exp_f32 v135, v135
    v_mfma_f32_32x32x8_bf16 v[116:131], v[42:43], v[28:29], v[116:131]
    v_exp_f32 v136, v136
    v_exp_f32 v137, v137
    s_add_u32 s64, s64, 82944
    v_exp_f32 v138, v138
    v_exp_f32 v139, v139
    s_waitcnt lgkmcnt(2)
    v_smfmac_f32_32x32x32_bf16 v[52:67], v[44:47], v[100:107], v32
    v_exp_f32 v140, v140
    v_exp_f32 v141, v141
    v_exp_f32 v142, v142
    v_exp_f32 v143, v143
    v_smfmac_f32_32x32x32_bf16 v[68:83], v[44:47], v[132:139], v32
    ds_read_b128 v[44:47], v35 offset:7680
    v_exp_f32 v144, v144
    v_exp_f32 v145, v145
    v_exp_f32 v146, v146
    v_exp_f32 v147, v147
    s_mov_b32 exec_hi, 0xffff
    buffer_load_dwordx4 v244, s[44:47], s64 offen lds
    s_mov_b32 exec_hi, -1
    s_waitcnt lgkmcnt(1)
    v_smfmac_f32_32x32x32_bf16 v[52:67], v[48:51], v[108:115], v32
    v_exp_f32 v84, v84
    v_exp_f32 v85, v85
    v_exp_f32 v86, v86
    v_exp_f32 v87, v87
    v_smfmac_f32_32x32x32_bf16 v[68:83], v[48:51], v[140:147], v32
    ds_read_b128 v[48:51], v35 offset:8320
    v_exp_f32 v88, v88
    v_exp_f32 v89, v89
    v_exp_f32 v90, v90
    v_exp_f32 v91, v91
    s_add_u32 m0, m0, 6144
    v_mfma_f32_32x32x16_bf16 v[100:115], v[36:39], v[16:19], 0
    v_exp_f32 v92, v92
    v_exp_f32 v93, v93
    buffer_load_dwordx4 v[148:151], v248, s[32:35], s51 offen
    v_exp_f32 v94, v94
    v_exp_f32 v95, v95
    v_mfma_f32_32x32x16_bf16 v[132:147], v[36:39], v[24:27], 0
    ds_read_b128 v[36:39], v33 offset:8192
    v_exp_f32 v96, v96
    v_exp_f32 v97, v97
    v_exp_f32 v98, v98
    v_exp_f32 v99, v99
    buffer_load_dwordx2 v[152:153], v249, s[32:35], s51 offen offset:64
    v_mfma_f32_32x32x8_bf16 v[100:115], v[42:43], v[22:23], v[100:115]
    v_exp_f32 v116, v116
    v_exp_f32 v117, v117
    s_mov_b32 exec_hi, 0xffff
    buffer_load_dwordx4 v245, s[44:47], s65 offen lds
    s_mov_b32 exec_hi, -1
    v_exp_f32 v118, v118
    v_exp_f32 v119, v119
    v_mfma_f32_32x32x8_bf16 v[132:147], v[42:43], v[30:31], v[132:147]
    ds_read_b128 v[40:43], v34 offset:1024
    v_exp_f32 v120, v120
    v_exp_f32 v121, v121
    v_exp_f32 v122, v122
    v_exp_f32 v123, v123
    s_waitcnt lgkmcnt(3)
    v_smfmac_f32_32x32x32_bf16 v[52:67], v[44:47], v[84:91], v32
    v_exp_f32 v124, v124
    v_exp_f32 v125, v125
    v_exp_f32 v126, v126
    v_exp_f32 v127, v127
    v_smfmac_f32_32x32x32_bf16 v[68:83], v[44:47], v[116:123], v32
    ds_read_b128 v[44:47], v35 offset:8960
    v_exp_f32 v128, v128
    v_exp_f32 v129, v129
    v_exp_f32 v130, v130
    v_exp_f32 v131, v131
    s_waitcnt lgkmcnt(1)
    v_smfmac_f32_32x32x32_bf16 v[52:67], v[48:51], v[92:99], v32
    v_exp_f32 v100, v100
    v_exp_f32 v101, v101
    v_exp_f32 v102, v102
    v_exp_f32 v103, v103
    v_smfmac_f32_32x32x32_bf16 v[68:83], v[48:51], v[124:131], v32
    ds_read_b128 v[48:51], v35 offset:9600
    v_exp_f32 v104, v104
    v_exp_f32 v105, v105
    v_exp_f32 v106, v106
    v_exp_f32 v107, v107
    v_mfma_f32_32x32x16_bf16 v[84:99], v[36:39], v[16:19], 0
    v_exp_f32 v108, v108
    v_exp_f32 v109, v109
    v_exp_f32 v110, v110
    v_exp_f32 v111, v111
    v_mfma_f32_32x32x16_bf16 v[116:131], v[36:39], v[24:27], 0
    ds_read_b128 v[36:39], v33 offset:9216
    v_exp_f32 v112, v112
    v_exp_f32 v113, v113
    v_exp_f32 v114, v114
    v_exp_f32 v115, v115
    v_mfma_f32_32x32x8_bf16 v[84:99], v[40:41], v[20:21], v[84:99]
    v_exp_f32 v132, v132
    v_exp_f32 v133, v133
    v_exp_f32 v134, v134
    v_exp_f32 v135, v135
    v_mfma_f32_32x32x8_bf16 v[116:131], v[40:41], v[28:29], v[116:131]
    v_exp_f32 v136, v136
    v_exp_f32 v137, v137
    v_exp_f32 v138, v138
    v_exp_f32 v139, v139
    s_waitcnt lgkmcnt(2)
    v_smfmac_f32_32x32x32_bf16 v[52:67], v[44:47], v[100:107], v32
    v_exp_f32 v140, v140
    v_exp_f32 v141, v141
    v_exp_f32 v142, v142
    v_exp_f32 v143, v143
    v_smfmac_f32_32x32x32_bf16 v[68:83], v[44:47], v[132:139], v32
    ds_read_b128 v[44:47], v35 offset:10240
    v_exp_f32 v144, v144
    v_exp_f32 v145, v145
    v_exp_f32 v146, v146
    v_exp_f32 v147, v147
    v_add_u32 v33, 8192, v33
    v_add_u32 v34, 1024, v34
    v_add_u32 v35, 10240, v35
    s_waitcnt lgkmcnt(1)
    v_smfmac_f32_32x32x32_bf16 v[52:67], v[48:51], v[108:115], v32
    v_smfmac_f32_32x32x32_bf16 v[68:83], v[48:51], v[140:147], v32
    s_setprio 0
L_att_done_47:
L_tail_start:
    s_nop 10
    ds_write_b128 v246, v[68:71] offset:0
    ds_write_b128 v246, v[72:75] offset:1024
    ds_write_b128 v246, v[76:79] offset:2048
    v_min_f32 v10, v62, v78
    v_max_f32 v11, v62, v78
    v_cmp_u_f32 s[92:93], v62, v78
    v_cmp_nlt_f32 vcc, 0x1f800000, v10
    v_mov_b32 v7, 156684
    s_or_b64 s[92:93], s[92:93], vcc
    v_cmp_ngt_f32 vcc, 0x5f800000, v11
    s_nop 0
    s_or_b64 vcc, s[92:93], vcc
    s_mov_b32 vcc_hi, 0
    s_cbranch_vccz L_voteok_67
    v_mov_b32 v8, 1
    ds_write_b32 v7, v8
L_voteok_67:
    s_waitcnt vmcnt(0) lgkmcnt(0)
    s_barrier
    ds_read_b128 v[84:87], v247 offset:0
    ds_read_b128 v[88:91], v247 offset:1024
    ds_read_b128 v[92:95], v247 offset:2048
    ds_read_b32 v8, v7
    s_waitcnt lgkmcnt(0)
    v_readfirstlane_b32 s90, v8
    v_pk_add_f32 v[52:53], v[52:53], v[84:85]
    v_pk_add_f32 v[54:55], v[54:55], v[86:87]
    v_pk_add_f32 v[56:57], v[56:57], v[88:89]
    v_pk_add_f32 v[58:59], v[58:59], v[90:91]
    v_pk_add_f32 v[60:61], v[60:61], v[92:93]
    v_add_f32 v62, v62, v94
    s_cmp_lg_u32 s90, 0
    s_cbranch_scc1 L_slow
L_join:
    v_mov_b32 v6, v62
    v_mov_b32 v7, v62
    v_mov_b32 v16, s88
    v_mov_b32 v17, 0
    v_permlane32_swap_b32 v6, v7
    v_rcp_f32 v8, v6
    v_lshlrev_b32 v18, 7, v2
    v_pk_mul_f32 v[52:53], v[52:53], v[8:9] op_sel_hi:[1,0]
    v_pk_mul_f32 v[54:55], v[54:55], v[8:9] op_sel_hi:[1,0]
    v_pk_mul_f32 v[56:57], v[56:57], v[8:9] op_sel_hi:[1,0]
    v_pk_mul_f32 v[58:59], v[58:59], v[8:9] op_sel_hi:[1,0]
    v_pk_mul_f32 v[60:61], v[60:61], v[8:9] op_sel_hi:[1,0]
    v_cvt_pk_bf16_f32 v12, v52, v53
    v_cvt_pk_bf16_f32 v13, v54, v55
    v_cvt_pk_bf16_f32 v14, v56, v57
    v_cvt_pk_bf16_f32 v15, v58, v59
    v_cvt_pk_bf16_f32 v10, v60, v61
    buffer_store_dwordx4 v[12:15], v5, s[80:83], s22 offen sc1
    buffer_store_dword v10, v238, s[80:83], s23 offen sc1
    ds_read_b64_tr_b16 v[188:189], v240 offset:0
    ds_read_b64_tr_b16 v[190:191], v241 offset:0
    ds_read_b64_tr_b16 v[192:193], v240 offset:32
    ds_read_b64_tr_b16 v[194:195], v241 offset:32
    ds_read_b64_tr_b16 v[196:197], v242 offset:0
    ds_read_b64_tr_b16 v[198:199], v243 offset:0
    ds_read_b64_tr_b16 v[200:201], v240 offset:3072
    ds_read_b64_tr_b16 v[202:203], v241 offset:3072
    ds_read_b64_tr_b16 v[204:205], v240 offset:3104
    ds_read_b64_tr_b16 v[206:207], v241 offset:3104
    ds_read_b64_tr_b16 v[208:209], v242 offset:3072
    ds_read_b64_tr_b16 v[210:211], v243 offset:3072
    v_lshlrev_b32 v19, 2, v1
    v_cvt_pk_bf16_f32 v4, v4, v4
    v_lshlrev_b32 v4, 16, v4
    v_mul_f32 v4, 0xbfb8aa3b, v4
    v_exp_f32 v4, v4
    s_nop 0
    v_add_f32 v4, 1.0, v4
    v_rcp_f32 v4, v4
    s_nop 0
    v_cvt_pk_bf16_f32 v4, v4, v4
    v_lshlrev_b32 v4, 16, v4
    v_sub_f32 v20, 1.0, v4
    v_cvt_pk_bf16_f32 v20, v20, v20
    v_lshlrev_b32 v20, 16, v20
    s_waitcnt vmcnt(0)
    s_barrier
    s_cmp_lg_u32 s84, 0
    s_cbranch_scc1 L_noflag_68
    buffer_store_dword v16, v17, s[80:83], s24 offen sc1
L_noflag_68:
    s_lshr_b32 s90, s98, 4
    s_cmp_lg_u32 s90, s87
    s_cbranch_scc1 L_ynot_70
    v_lshlrev_b32 v8, 7, v1
    s_mov_b32 s90, 212992
    s_mov_b32 s3, 400000
L_ypoll_71:
    s_add_u32 s91, s90, 0
    buffer_load_dword v10, v8, s[80:83], s91 offen sc1
    s_add_u32 s91, s90, 8192
    buffer_load_dword v11, v8, s[80:83], s91 offen sc1
    s_add_u32 s91, s90, 16384
    buffer_load_dword v12, v8, s[80:83], s91 offen sc1
    s_waitcnt vmcnt(0)
    v_cmp_ne_u32 vcc, s88, v10
    v_cmp_ne_u32 s[92:93], s88, v11
    s_nop 0
    s_or_b64 vcc, vcc, s[92:93]
    v_cmp_ne_u32 s[92:93], s88, v12
    s_nop 0
    s_or_b64 vcc, vcc, s[92:93]
    s_cbranch_vccz L_ypoll_done_72
    s_sub_u32 s3, s3, 1
    s_cbranch_scc1 L_ypoll_done_72
    s_branch L_ypoll_71
L_ypoll_done_72:
    v_min_u32 v6, 35, v1
    v_and_b32 v7, 1, v6
    v_mul_u32_u24 v7, 1152, v7
    v_lshrrev_b32 v6, 1, v6
    v_lshl_add_u32 v6, v6, 2, v7
    s_mul_i32 s90, s86, 72
    s_add_u32 s90, s90, 159744
    s_add_u32 s91, s90, 0
    buffer_load_dword v10, v6, s[80:83], s91 offen sc1
    s_add_u32 s91, s90, 4608
    buffer_load_dword v11, v6, s[80:83], s91 offen sc1
    s_add_u32 s91, s90, 9216
    buffer_load_dword v12, v6, s[80:83], s91 offen sc1
    s_add_u32 s91, s90, 13824
    buffer_load_dword v13, v6, s[80:83], s91 offen sc1
    s_and_b32 s92, s100, 0xfffff800
    s_ashr_i32 s93, s92, 31
    s_not_b32 s93, s93
    s_or_b32 s93, s93, 0x80000000
    s_xor_b32 s92, s92, s93
    v_mov_b32 v15, s92
    v_cvt_pk_bf16_f32 v15, v15, v15
    v_lshlrev_b32 v15, 16, v15
    v_mul_f32 v15, 0xbfb8aa3b, v15
    v_exp_f32 v15, v15
    s_nop 0
    v_add_f32 v15, 1.0, v15
    v_rcp_f32 v15, v15
    s_nop 0
    v_cvt_pk_bf16_f32 v15, v15, v15
    v_lshlrev_b32 v15, 16, v15
    s_waitcnt vmcnt(0)
    v_add_f32 v10, v10, v11
    v_add_f32 v12, v12, v13
    v_add_f32 v10, v10, v12
    v_cvt_pk_bf16_f32 v10, v10, v10
    v_lshlrev_b32 v10, 16, v10
    v_mul_f32 v10, v15, v10
    v_cvt_pk_bf16_f32 v10, v10, v10
    v_lshlrev_b32 v10, 16, v10
    s_mul_i32 s90, s84, 320
    s_add_u32 s90, s90, 157184
    v_lshlrev_b32 v6, 2, v1
    v_add_u32 v6, s90, v6
    v_cmp_gt_u32 vcc, 36, v1
    s_nop 0
    s_and_saveexec_b64 s[96:97], vcc
    s_cbranch_execz L_skip_73
    ds_write_b32 v6, v10
L_skip_73:
    s_mov_b64 exec, s[96:97]
    s_waitcnt lgkmcnt(0)
L_ynot_70:
    s_lshr_b32 s90, s99, 4
    s_cmp_lg_u32 s90, s87
    s_cbranch_scc1 L_ynot_74
    v_lshlrev_b32 v8, 7, v1
    s_mov_b32 s90, 212992
    s_mov_b32 s3, 400000
L_ypoll_75:
    s_add_u32 s91, s90, 0
    buffer_load_dword v10, v8, s[80:83], s91 offen sc1
    s_add_u32 s91, s90, 8192
    buffer_load_dword v11, v8, s[80:83], s91 offen sc1
    s_add_u32 s91, s90, 16384
    buffer_load_dword v12, v8, s[80:83], s91 offen sc1
    s_waitcnt vmcnt(0)
    v_cmp_ne_u32 vcc, s88, v10
    v_cmp_ne_u32 s[92:93], s88, v11
    s_nop 0
    s_or_b64 vcc, vcc, s[92:93]
    v_cmp_ne_u32 s[92:93], s88, v12
    s_nop 0
    s_or_b64 vcc, vcc, s[92:93]
    s_cbranch_vccz L_ypoll_done_76
    s_sub_u32 s3, s3, 1
    s_cbranch_scc1 L_ypoll_done_76
    s_branch L_ypoll_75
L_ypoll_done_76:
    v_min_u32 v6, 35, v1
    v_and_b32 v7, 1, v6
    v_mul_u32_u24 v7, 1152, v7
    v_lshrrev_b32 v6, 1, v6
    v_lshl_add_u32 v6, v6, 2, v7
    s_mul_i32 s90, s86, 72
    s_add_u32 s90, s90, 162048
    s_add_u32 s91, s90, 0
    buffer_load_dword v10, v6, s[80:83], s91 offen sc1
    s_add_u32 s91, s90, 4608
    buffer_load_dword v11, v6, s[80:83], s91 offen sc1
    s_add_u32 s91, s90, 9216
    buffer_load_dword v12, v6, s[80:83], s91 offen sc1
    s_add_u32 s91, s90, 13824
    buffer_load_dword v13, v6, s[80:83], s91 offen sc1
    s_and_b32 s92, s101, 0xfffff800
    s_ashr_i32 s93, s92, 31
    s_not_b32 s93, s93
    s_or_b32 s93, s93, 0x80000000
    s_xor_b32 s92, s92, s93
    v_mov_b32 v15, s92
    v_cvt_pk_bf16_f32 v15, v15, v15
    v_lshlrev_b32 v15, 16, v15
    v_mul_f32 v15, 0xbfb8aa3b, v15
    v_exp_f32 v15, v15
    s_nop 0
    v_add_f32 v15, 1.0, v15
    v_rcp_f32 v15, v15
    s_nop 0
    v_cvt_pk_bf16_f32 v15, v15, v15
    v_lshlrev_b32 v15, 16, v15
    s_waitcnt vmcnt(0)
    v_add_f32 v10, v10, v11
    v_add_f32 v12, v12, v13
    v_add_f32 v10, v10, v12
    v_cvt_pk_bf16_f32 v10, v10, v10
    v_lshlrev_b32 v10, 16, v10
    v_mul_f32 v10, v15, v10
    v_cvt_pk_bf16_f32 v10, v10, v10
    v_lshlrev_b32 v10, 16, v10
    s_mul_i32 s90, s84, 320
    s_add_u32 s90, s90, 157344
    v_lshlrev_b32 v6, 2, v1
    v_add_u32 v6, s90, v6
    v_cmp_gt_u32 vcc, 36, v1
    s_nop 0
    s_and_saveexec_b64 s[96:97], vcc
    s_cbranch_execz L_skip_77
    ds_write_b32 v6, v10
L_skip_77:
    s_mov_b64 exec, s[96:97]
    s_waitcnt lgkmcnt(0)
L_ynot_74:
    v_lshlrev_b32 v24, 16, v148
    v_and_b32 v25, 0xffff0000, v148
    v_lshlrev_b32 v26, 16, v149
    v_and_b32 v27, 0xffff0000, v149
    v_lshlrev_b32 v28, 16, v150
    v_and_b32 v29, 0xffff0000, v150
    v_lshlrev_b32 v30, 16, v151
    v_and_b32 v31, 0xffff0000, v151
    v_lshlrev_b32 v32, 16, v152
    v_and_b32 v33, 0xffff0000, v152
    v_lshlrev_b32 v34, 16, v153
    v_and_b32 v35, 0xffff0000, v153
    s_lshr_b32 s90, s98, 4
    s_cmp_lg_u32 s90, s87
    s_cbranch_scc1 L_fnot_78
    s_mul_i32 s90, s84, 320
    s_add_u32 s90, s90, 157184
    v_lshlrev_b32 v7, 5, v3
    v_add_u32 v7, s90, v7
    v_mov_b32 v8, s90
    ds_read_b128 v[36:39], v7
    ds_read_b128 v[40:43], v7 offset:16
    ds_read_b128 v[44:47], v8 offset:128
    s_and_b32 s90, s98, 15
    s_waitcnt lgkmcnt(0)
    v_cmp_eq_u32 vcc, s90, v2
    s_nop 0
    s_and_saveexec_b64 s[96:97], vcc
    s_cbranch_execz L_skip_79
    v_add_f32 v24, v24, v36
    v_cvt_pk_bf16_f32 v24, v24, v24
    v_lshlrev_b32 v24, 16, v24
    v_add_f32 v25, v25, v37
    v_cvt_pk_bf16_f32 v25, v25, v25
    v_lshlrev_b32 v25, 16, v25
    v_add_f32 v26, v26, v38
    v_cvt_pk_bf16_f32 v26, v26, v26
    v_lshlrev_b32 v26, 16, v26
    v_add_f32 v27, v27, v39
    v_cvt_pk_bf16_f32 v27, v27, v27
    v_lshlrev_b32 v27, 16, v27
    v_add_f32 v28, v28, v40
    v_cvt_pk_bf16_f32 v28, v28, v28
    v_lshlrev_b32 v28, 16, v28
    v_add_f32 v29, v29, v41
    v_cvt_pk_bf16_f32 v29, v29, v29
    v_lshlrev_b32 v29, 16, v29
    v_add_f32 v30, v30, v42
    v_cvt_pk_bf16_f32 v30, v30, v30
    v_lshlrev_b32 v30, 16, v30
    v_add_f32 v31, v31, v43
    v_cvt_pk_bf16_f32 v31, v31, v31
    v_lshlrev_b32 v31, 16, v31
    v_add_f32 v32, v32, v44
    v_cvt_pk_bf16_f32 v32, v32, v32
    v_lshlrev_b32 v32, 16, v32
    v_add_f32 v33, v33, v45
    v_cvt_pk_bf16_f32 v33, v33, v33
    v_lshlrev_b32 v33, 16, v33
    v_add_f32 v34, v34, v46
    v_cvt_pk_bf16_f32 v34, v34, v34
    v_lshlrev_b32 v34, 16, v34
    v_add_f32 v35, v35, v47
    v_cvt_pk_bf16_f32 v35, v35, v35
    v_lshlrev_b32 v35, 16, v35
L_skip_79:
    s_mov_b64 exec, s[96:97]
L_fnot_78:
    s_lshr_b32 s90, s99, 4
    s_cmp_lg_u32 s90, s87
    s_cbranch_scc1 L_fnot_80
    s_mul_i32 s90, s84, 320
    s_add_u32 s90, s90, 157344
    v_lshlrev_b32 v7, 5, v3
    v_add_u32 v7, s90, v7
    v_mov_b32 v8, s90
    ds_read_b128 v[36:39], v7
    ds_read_b128 v[40:43], v7 offset:16
    ds_read_b128 v[44:47], v8 offset:128
    s_and_b32 s90, s99, 15
    s_waitcnt lgkmcnt(0)
    v_cmp_eq_u32 vcc, s90, v2
    s_nop 0
    s_and_saveexec_b64 s[96:97], vcc
    s_cbranch_execz L_skip_81
    v_add_f32 v24, v24, v36
    v_cvt_pk_bf16_f32 v24, v24, v24
    v_lshlrev_b32 v24, 16, v24
    v_add_f32 v25, v25, v37
    v_cvt_pk_bf16_f32 v25, v25, v25
    v_lshlrev_b32 v25, 16, v25
    v_add_f32 v26, v26, v38
    v_cvt_pk_bf16_f32 v26, v26, v26
    v_lshlrev_b32 v26, 16, v26
    v_add_f32 v27, v27, v39
    v_cvt_pk_bf16_f32 v27, v27, v27
    v_lshlrev_b32 v27, 16, v27
    v_add_f32 v28, v28, v40
    v_cvt_pk_bf16_f32 v28, v28, v28
    v_lshlrev_b32 v28, 16, v28
    v_add_f32 v29, v29, v41
    v_cvt_pk_bf16_f32 v29, v29, v29
    v_lshlrev_b32 v29, 16, v29
    v_add_f32 v30, v30, v42
    v_cvt_pk_bf16_f32 v30, v30, v30
    v_lshlrev_b32 v30, 16, v30
    v_add_f32 v31, v31, v43
    v_cvt_pk_bf16_f32 v31, v31, v31
    v_lshlrev_b32 v31, 16, v31
    v_add_f32 v32, v32, v44
    v_cvt_pk_bf16_f32 v32, v32, v32
    v_lshlrev_b32 v32, 16, v32
    v_add_f32 v33, v33, v45
    v_cvt_pk_bf16_f32 v33, v33, v33
    v_lshlrev_b32 v33, 16, v33
    v_add_f32 v34, v34, v46
    v_cvt_pk_bf16_f32 v34, v34, v34
    v_lshlrev_b32 v34, 16, v34
    v_add_f32 v35, v35, v47
    v_cvt_pk_bf16_f32 v35, v35, v35
    v_lshlrev_b32 v35, 16, v35
L_skip_81:
    s_mov_b64 exec, s[96:97]
L_fnot_80:
    v_pk_mul_f32 v[24:25], v[20:21], v[24:25] op_sel_hi:[0,1]
    v_pk_mul_f32 v[26:27], v[20:21], v[26:27] op_sel_hi:[0,1]
    v_pk_mul_f32 v[28:29], v[20:21], v[28:29] op_sel_hi:[0,1]
    v_pk_mul_f32 v[30:31], v[20:21], v[30:31] op_sel_hi:[0,1]
    v_pk_mul_f32 v[32:33], v[20:21], v[32:33] op_sel_hi:[0,1]
    v_pk_mul_f32 v[34:35], v[20:21], v[34:35] op_sel_hi:[0,1]
    s_cmp_lg_u32 s84, 0
    s_cbranch_scc1 L_nopoll_69
    s_mov_b32 s3, 400000
L_o_poll_82:
    buffer_load_dword v9, v18, s[80:83], s27 offen sc1
    s_waitcnt vmcnt(0)
    v_cmp_ne_u32 vcc, s88, v9
    s_cbranch_vccz L_o_poll_done_83
    s_sub_u32 s3, s3, 1
    s_cbranch_scc1 L_o_poll_done_83
    s_branch L_o_poll_82
L_o_poll_done_83:
L_nopoll_69:
    s_barrier
    buffer_load_dwordx4 v[64:67], v5, s[80:83], s25 offen offset:0 sc1
    buffer_load_dwordx4 v[68:71], v5, s[80:83], s25 offen offset:1024 sc1
    buffer_load_dwordx4 v[72:75], v5, s[80:83], s25 offen offset:2048 sc1
    buffer_load_dwordx4 v[76:79], v5, s[80:83], s25 offen offset:3072 sc1
    s_add_u32 s25, s25, 4096
    buffer_load_dwordx4 v[80:83], v5, s[80:83], s25 offen offset:0 sc1
    buffer_load_dwordx4 v[84:87], v5, s[80:83], s25 offen offset:1024 sc1
    buffer_load_dwordx4 v[88:91], v5, s[80:83], s25 offen offset:2048 sc1
    buffer_load_dwordx4 v[92:95], v5, s[80:83], s25 offen offset:3072 sc1
    s_add_u32 s25, s25, 4096
    buffer_load_dwordx4 v[96:99], v5, s[80:83], s25 offen offset:0 sc1
    buffer_load_dwordx4 v[100:103], v5, s[80:83], s25 offen offset:1024 sc1
    buffer_load_dwordx4 v[104:107], v5, s[80:83], s25 offen offset:2048 sc1
    buffer_load_dwordx4 v[108:111], v5, s[80:83], s25 offen offset:3072 sc1
    s_add_u32 s25, s25, 4096
    buffer_load_dwordx4 v[112:115], v5, s[80:83], s25 offen offset:0 sc1
    buffer_load_dwordx4 v[116:119], v5, s[80:83], s25 offen offset:1024 sc1
    buffer_load_dwordx4 v[120:123], v5, s[80:83], s25 offen offset:2048 sc1
    buffer_load_dwordx4 v[124:127], v5, s[80:83], s25 offen offset:3072 sc1
    buffer_load_dword v128, v19, s[80:83], s26 offen offset:0 sc1
    buffer_load_dword v129, v19, s[80:83], s26 offen offset:256 sc1
    buffer_load_dword v130, v19, s[80:83], s26 offen offset:512 sc1
    buffer_load_dword v131, v19, s[80:83], s26 offen offset:768 sc1
    buffer_load_dword v132, v19, s[80:83], s26 offen offset:1024 sc1
    buffer_load_dword v133, v19, s[80:83], s26 offen offset:1280 sc1
    buffer_load_dword v134, v19, s[80:83], s26 offen offset:1536 sc1
    buffer_load_dword v135, v19, s[80:83], s26 offen offset:1792 sc1
    s_waitcnt lgkmcnt(6)
    s_waitcnt vmcnt(20)
    v_mfma_f32_16x16x32_bf16 v[224:227], v[188:191], v[64:67], 0
    ds_read_b64_tr_b16 v[212:213], v240 offset:6144
    ds_read_b64_tr_b16 v[214:215], v241 offset:6144
    v_mfma_f32_16x16x32_bf16 v[228:231], v[192:195], v[64:67], 0
    ds_read_b64_tr_b16 v[216:217], v240 offset:6176
    ds_read_b64_tr_b16 v[218:219], v241 offset:6176
    v_mfma_f32_16x16x32_bf16 v[232:235], v[196:199], v[64:67], 0
    ds_read_b64_tr_b16 v[220:221], v242 offset:6144
    ds_read_b64_tr_b16 v[222:223], v243 offset:6144
    s_waitcnt lgkmcnt(6)
    v_mfma_f32_16x16x32_bf16 v[224:227], v[200:203], v[68:71], v[224:227]
    ds_read_b64_tr_b16 v[188:189], v240 offset:9216
    ds_read_b64_tr_b16 v[190:191], v241 offset:9216
    v_mfma_f32_16x16x32_bf16 v[228:231], v[204:207], v[68:71], v[228:231]
    ds_read_b64_tr_b16 v[192:193], v240 offset:9248
    ds_read_b64_tr_b16 v[194:195], v241 offset:9248
    v_mfma_f32_16x16x32_bf16 v[232:235], v[208:211], v[68:71], v[232:235]
    ds_read_b64_tr_b16 v[196:197], v242 offset:9216
    ds_read_b64_tr_b16 v[198:199], v243 offset:9216
    s_waitcnt lgkmcnt(6)
    v_mfma_f32_16x16x32_bf16 v[224:227], v[212:215], v[72:75], v[224:227]
    ds_read_b64_tr_b16 v[200:201], v240 offset:12288
    ds_read_b64_tr_b16 v[202:203], v241 offset:12288
    v_mfma_f32_16x16x32_bf16 v[228:231], v[216:219], v[72:75], v[228:231]
    ds_read_b64_tr_b16 v[204:205], v240 offset:12320
    ds_read_b64_tr_b16 v[206:207], v241 offset:12320
    v_mfma_f32_16x16x32_bf16 v[232:235], v[220:223], v[72:75], v[232:235]
    ds_read_b64_tr_b16 v[208:209], v242 offset:12288
    ds_read_b64_tr_b16 v[210:211], v243 offset:12288
    s_waitcnt lgkmcnt(6)
    v_mfma_f32_16x16x32_bf16 v[224:227], v[188:191], v[76:79], v[224:227]
    ds_read_b64_tr_b16 v[212:213], v240 offset:15360
    ds_read_b64_tr_b16 v[214:215], v241 offset:15360
    v_mfma_f32_16x16x32_bf16 v[228:231], v[192:195], v[76:79], v[228:231]
    ds_read_b64_tr_b16 v[216:217], v240 offset:15392
    ds_read_b64_tr_b16 v[218:219], v241 offset:15392
    v_mfma_f32_16x16x32_bf16 v[232:235], v[196:199], v[76:79], v[232:235]
    ds_read_b64_tr_b16 v[220:221], v242 offset:15360
    ds_read_b64_tr_b16 v[222:223], v243 offset:15360
    s_waitcnt lgkmcnt(6)
    s_waitcnt vmcnt(16)
    v_mfma_f32_16x16x32_bf16 v[224:227], v[200:203], v[80:83], v[224:227]
    ds_read_b64_tr_b16 v[188:189], v240 offset:18432
    ds_read_b64_tr_b16 v[190:191], v241 offset:18432
    v_mfma_f32_16x16x32_bf16 v[228:231], v[204:207], v[80:83], v[228:231]
    ds_read_b64_tr_b16 v[192:193], v240 offset:18464
    ds_read_b64_tr_b16 v[194:195], v241 offset:18464
    v_mfma_f32_16x16x32_bf16 v[232:235], v[208:211], v[80:83], v[232:235]
    ds_read_b64_tr_b16 v[196:197], v242 offset:18432
    ds_read_b64_tr_b16 v[198:199], v243 offset:18432
    s_waitcnt lgkmcnt(6)
    v_mfma_f32_16x16x32_bf16 v[224:227], v[212:215], v[84:87], v[224:227]
    ds_read_b64_tr_b16 v[200:201], v240 offset:21504
    ds_read_b64_tr_b16 v[202:203], v241 offset:21504
    v_mfma_f32_16x16x32_bf16 v[228:231], v[216:219], v[84:87], v[228:231]
    ds_read_b64_tr_b16 v[204:205], v240 offset:21536
    ds_read_b64_tr_b16 v[206:207], v241 offset:21536
    v_mfma_f32_16x16x32_bf16 v[232:235], v[220:223], v[84:87], v[232:235]
    ds_read_b64_tr_b16 v[208:209], v242 offset:21504
    ds_read_b64_tr_b16 v[210:211], v243 offset:21504
    s_waitcnt lgkmcnt(6)
    v_mfma_f32_16x16x32_bf16 v[224:227], v[188:191], v[88:91], v[224:227]
    ds_read_b64_tr_b16 v[212:213], v240 offset:24576
    ds_read_b64_tr_b16 v[214:215], v241 offset:24576
    v_mfma_f32_16x16x32_bf16 v[228:231], v[192:195], v[88:91], v[228:231]
    ds_read_b64_tr_b16 v[216:217], v240 offset:24608
    ds_read_b64_tr_b16 v[218:219], v241 offset:24608
    v_mfma_f32_16x16x32_bf16 v[232:235], v[196:199], v[88:91], v[232:235]
    ds_read_b64_tr_b16 v[220:221], v242 offset:24576
    ds_read_b64_tr_b16 v[222:223], v243 offset:24576
    s_waitcnt lgkmcnt(6)
    v_mfma_f32_16x16x32_bf16 v[224:227], v[200:203], v[92:95], v[224:227]
    v_add_u32 v240, 40960, v240
    v_add_u32 v241, 40960, v241
    v_add_u32 v242, 40960, v242
    v_add_u32 v243, 40960, v243
    ds_read_b64_tr_b16 v[188:189], v240 offset:0
    ds_read_b64_tr_b16 v[190:191], v241 offset:0
    v_mfma_f32_16x16x32_bf16 v[228:231], v[204:207], v[92:95], v[228:231]
    ds_read_b64_tr_b16 v[192:193], v240 offset:32
    ds_read_b64_tr_b16 v[194:195], v241 offset:32
    v_mfma_f32_16x16x32_bf16 v[232:235], v[208:211], v[92:95], v[232:235]
    ds_read_b64_tr_b16 v[196:197], v242 offset:0
    ds_read_b64_tr_b16 v[198:199], v243 offset:0
    s_waitcnt lgkmcnt(6)
    s_waitcnt vmcnt(12)
    v_mfma_f32_16x16x32_bf16 v[224:227], v[212:215], v[96:99], v[224:227]
    ds_read_b64_tr_b16 v[200:201], v240 offset:3072
    ds_read_b64_tr_b16 v[202:203], v241 offset:3072
    v_mfma_f32_16x16x32_bf16 v[228:231], v[216:219], v[96:99], v[228:231]
    ds_read_b64_tr_b16 v[204:205], v240 offset:3104
    ds_read_b64_tr_b16 v[206:207], v241 offset:3104
    v_mfma_f32_16x16x32_bf16 v[232:235], v[220:223], v[96:99], v[232:235]
    ds_read_b64_tr_b16 v[208:209], v242 offset:3072
    ds_read_b64_tr_b16 v[210:211], v243 offset:3072
    s_waitcnt lgkmcnt(6)
    v_mfma_f32_16x16x32_bf16 v[224:227], v[188:191], v[100:103], v[224:227]
    ds_read_b64_tr_b16 v[212:213], v240 offset:6144
    ds_read_b64_tr_b16 v[214:215], v241 offset:6144
    v_mfma_f32_16x16x32_bf16 v[228:231], v[192:195], v[100:103], v[228:231]
    ds_read_b64_tr_b16 v[216:217], v240 offset:6176
    ds_read_b64_tr_b16 v[218:219], v241 offset:6176
    v_mfma_f32_16x16x32_bf16 v[232:235], v[196:199], v[100:103], v[232:235]
    ds_read_b64_tr_b16 v[220:221], v242 offset:6144
    ds_read_b64_tr_b16 v[222:223], v243 offset:6144
    s_waitcnt lgkmcnt(6)
    v_mfma_f32_16x16x32_bf16 v[224:227], v[200:203], v[104:107], v[224:227]
    ds_read_b64_tr_b16 v[188:189], v240 offset:9216
    ds_read_b64_tr_b16 v[190:191], v241 offset:9216
    v_mfma_f32_16x16x32_bf16 v[228:231], v[204:207], v[104:107], v[228:231]
    ds_read_b64_tr_b16 v[192:193], v240 offset:9248
    ds_read_b64_tr_b16 v[194:195], v241 offset:9248
    v_mfma_f32_16x16x32_bf16 v[232:235], v[208:211], v[104:107], v[232:235]
    ds_read_b64_tr_b16 v[196:197], v242 offset:9216
    ds_read_b64_tr_b16 v[198:199], v243 offset:9216
    s_waitcnt lgkmcnt(6)
    v_mfma_f32_16x16x32_bf16 v[224:227], v[212:215], v[108:111], v[224:227]
    ds_read_b64_tr_b16 v[200:201], v240 offset:12288
    ds_read_b64_tr_b16 v[202:203], v241 offset:12288
    v_mfma_f32_16x16x32_bf16 v[228:231], v[216:219], v[108:111], v[228:231]
    ds_read_b64_tr_b16 v[204:205], v240 offset:12320
    ds_read_b64_tr_b16 v[206:207], v241 offset:12320
    v_mfma_f32_16x16x32_bf16 v[232:235], v[220:223], v[108:111], v[232:235]
    ds_read_b64_tr_b16 v[208:209], v242 offset:12288
    ds_read_b64_tr_b16 v[210:211], v243 offset:12288
    s_waitcnt lgkmcnt(6)
    s_waitcnt vmcnt(8)
    v_mfma_f32_16x16x32_bf16 v[224:227], v[188:191], v[112:115], v[224:227]
    ds_read_b64_tr_b16 v[212:213], v240 offset:15360
    ds_read_b64_tr_b16 v[214:215], v241 offset:15360
    v_mfma_f32_16x16x32_bf16 v[228:231], v[192:195], v[112:115], v[228:231]
    ds_read_b64_tr_b16 v[216:217], v240 offset:15392
    ds_read_b64_tr_b16 v[218:219], v241 offset:15392
    v_mfma_f32_16x16x32_bf16 v[232:235], v[196:199], v[112:115], v[232:235]
    ds_read_b64_tr_b16 v[220:221], v242 offset:15360
    ds_read_b64_tr_b16 v[222:223], v243 offset:15360
    s_waitcnt lgkmcnt(6)
    v_mfma_f32_16x16x32_bf16 v[224:227], v[200:203], v[116:119], v[224:227]
    ds_read_b64_tr_b16 v[188:189], v240 offset:18432
    ds_read_b64_tr_b16 v[190:191], v241 offset:18432
    v_mfma_f32_16x16x32_bf16 v[228:231], v[204:207], v[116:119], v[228:231]
    ds_read_b64_tr_b16 v[192:193], v240 offset:18464
    ds_read_b64_tr_b16 v[194:195], v241 offset:18464
    v_mfma_f32_16x16x32_bf16 v[232:235], v[208:211], v[116:119], v[232:235]
    ds_read_b64_tr_b16 v[196:197], v242 offset:18432
    ds_read_b64_tr_b16 v[198:199], v243 offset:18432
    s_waitcnt lgkmcnt(6)
    v_mfma_f32_16x16x32_bf16 v[224:227], v[212:215], v[120:123], v[224:227]
    ds_read_b64_tr_b16 v[200:201], v240 offset:21504
    ds_read_b64_tr_b16 v[202:203], v241 offset:21504
    v_mfma_f32_16x16x32_bf16 v[228:231], v[216:219], v[120:123], v[228:231]
    ds_read_b64_tr_b16 v[204:205], v240 offset:21536
    ds_read_b64_tr_b16 v[206:207], v241 offset:21536
    v_mfma_f32_16x16x32_bf16 v[232:235], v[220:223], v[120:123], v[232:235]
    ds_read_b64_tr_b16 v[208:209], v242 offset:21504
    ds_read_b64_tr_b16 v[210:211], v243 offset:21504
    s_waitcnt lgkmcnt(6)
    v_mfma_f32_16x16x32_bf16 v[224:227], v[188:191], v[124:127], v[224:227]
    ds_read_b64_tr_b16 v[212:213], v240 offset:24576
    ds_read_b64_tr_b16 v[214:215], v241 offset:24576
    v_mfma_f32_16x16x32_bf16 v[228:231], v[192:195], v[124:127], v[228:231]
    ds_read_b64_tr_b16 v[216:217], v240 offset:24608
    ds_read_b64_tr_b16 v[218:219], v241 offset:24608
    v_mfma_f32_16x16x32_bf16 v[232:235], v[196:199], v[124:127], v[232:235]
    ds_read_b64_tr_b16 v[220:221], v242 offset:24576
    ds_read_b64_tr_b16 v[222:223], v243 offset:24576
    s_waitcnt lgkmcnt(6)
    s_waitcnt vmcnt(0)
    v_mfma_f32_16x16x32_bf16 v[224:227], v[200:203], v[128:131], v[224:227]
    v_mfma_f32_16x16x32_bf16 v[228:231], v[204:207], v[128:131], v[228:231]
    v_mfma_f32_16x16x32_bf16 v[232:235], v[208:211], v[128:131], v[232:235]
    s_waitcnt lgkmcnt(0)
    v_mfma_f32_16x16x32_bf16 v[224:227], v[212:215], v[132:135], v[224:227]
    v_mfma_f32_16x16x32_bf16 v[228:231], v[216:219], v[132:135], v[228:231]
    v_mfma_f32_16x16x32_bf16 v[232:235], v[220:223], v[132:135], v[232:235]
    s_nop 6
    v_permlane32_swap_b32 v224, v228
    v_permlane32_swap_b32 v225, v229
    v_permlane32_swap_b32 v226, v230
    v_permlane32_swap_b32 v227, v231
    v_mov_b32 v8, v4
    s_nop 0
    v_permlane16_swap_b32 v224, v228
    v_permlane16_swap_b32 v225, v229
    v_permlane16_swap_b32 v226, v230
    v_permlane16_swap_b32 v227, v231
    v_pk_fma_f32 v[32:33], v[8:9], v[232:233], v[32:33] op_sel_hi:[0,1,1]
    v_pk_fma_f32 v[34:35], v[8:9], v[234:235], v[34:35] op_sel_hi:[0,1,1]
    v_pk_fma_f32 v[24:25], v[8:9], v[224:225], v[24:25] op_sel_hi:[0,1,1]
    v_pk_fma_f32 v[26:27], v[8:9], v[226:227], v[26:27] op_sel_hi:[0,1,1]
    v_pk_fma_f32 v[28:29], v[8:9], v[228:229], v[28:29] op_sel_hi:[0,1,1]
    v_pk_fma_f32 v[30:31], v[8:9], v[230:231], v[30:31] op_sel_hi:[0,1,1]
    v_cvt_pk_bf16_f32 v48, v24, v25
    v_cvt_pk_bf16_f32 v49, v26, v27
    v_cvt_pk_bf16_f32 v50, v28, v29
    v_cvt_pk_bf16_f32 v51, v30, v31
    v_cvt_pk_bf16_f32 v52, v32, v33
    v_cvt_pk_bf16_f32 v53, v34, v35
    buffer_store_dwordx4 v[48:51], v248, s[72:75], s51 offen
    v_cmp_gt_u32 vcc, 16, v1
    s_nop 0
    s_and_saveexec_b64 s[96:97], vcc
    s_cbranch_execz L_skip_84
    buffer_store_dwordx2 v[52:53], v249, s[72:75], s51 offen offset:64
L_skip_84:
    s_mov_b64 exec, s[96:97]
    s_endpgm
L_slow:
    s_waitcnt vmcnt(0) lgkmcnt(0)
    s_barrier
    s_lshl_b32 s95, s50, 12
    s_lshl_b32 s91, s48, 12
    s_lshl_b32 s90, s50, 10
    s_add_u32 s90, s90, s91
    s_add_u32 s90, s90, 65536
    s_mov_b32 m0, s90
    s_lshl_b32 s64, s48, 15
    buffer_load_dwordx4 v5, s[80:83], s90 offen sc1 lds
    s_add_u32 s64, s64, s95
    s_mul_i32 s93, s48, 40960
    s_mov_b32 m0, s64
    s_add_u32 s93, s93, 73728
    buffer_load_dwordx4 v5, s[80:83], s64 offen sc1 lds
    buffer_load_dwordx4 v5, s[80:83], s64 offen offset:1024 sc1 lds
    buffer_load_dwordx4 v5, s[80:83], s64 offen offset:2048 sc1 lds
    buffer_load_dwordx4 v5, s[80:83], s64 offen offset:3072 sc1 lds
    s_add_u32 s65, s93, s95
    s_mov_b32 m0, s65
    s_lshl_b32 s95, s50, 11
    buffer_load_dwordx4 v5, s[80:83], s65 offen sc1 lds
    buffer_load_dwordx4 v5, s[80:83], s65 offen offset:1024 sc1 lds
    buffer_load_dwordx4 v5, s[80:83], s65 offen offset:2048 sc1 lds
    buffer_load_dwordx4 v5, s[80:83], s65 offen offset:3072 sc1 lds
    s_add_u32 s66, s93, s95
    s_add_u32 s66, s66, 32768
    s_add_u32 s64, s64, 16384
    s_add_u32 s65, s65, 16384
    s_nop 0
    s_mov_b32 m0, s64
    s_nop 0
    buffer_load_dwordx4 v5, s[80:83], s64 offen sc1 lds
    s_nop 0
    buffer_load_dwordx4 v5, s[80:83], s64 offen offset:1024 sc1 lds
    s_nop 0
    buffer_load_dwordx4 v5, s[80:83], s64 offen offset:2048 sc1 lds
    s_nop 0
    buffer_load_dwordx4 v5, s[80:83], s64 offen offset:3072 sc1 lds
    s_nop 0
    s_mov_b32 m0, s65
    s_nop 0
    buffer_load_dwordx4 v5, s[80:83], s65 offen sc1 lds
    s_nop 0
    buffer_load_dwordx4 v5, s[80:83], s65 offen offset:1024 sc1 lds
    s_nop 0
    buffer_load_dwordx4 v5, s[80:83], s65 offen offset:2048 sc1 lds
    s_nop 0
    buffer_load_dwordx4 v5, s[80:83], s65 offen offset:3072 sc1 lds
    s_nop 0
    s_mov_b32 m0, s66
    s_nop 0
    buffer_load_dwordx4 v5, s[80:83], s66 offen sc1 lds
    s_nop 0
    buffer_load_dwordx4 v5, s[80:83], s66 offen offset:1024 sc1 lds
    s_nop 0
    s_waitcnt vmcnt(0)
    s_barrier
    v_and_b32 v6, 31, v1
    v_lshrrev_b32 v8, 5, v1
    v_lshlrev_b32 v7, 4, v6
    v_min_u32 v6, 19, v6
    v_mul_u32_u24 v8, 320, v8
    v_lshl_add_u32 v8, v6, 4, v8
    v_mov_b32 v33, v5
    v_add_u32 v34, 65536, v7
    v_add_u32 v35, 73728, v8
    v_mov_b32 v32, 0xdddddddd
    v_mov_b32 v100, 0xff800000
    v_mov_b32 v41, 0
    s_mov_b32 s94, 0
L_slow1_85:
    s_lshr_b32 s90, s94, 2
    s_lshl_b32 s90, s90, 9
    s_and_b32 s91, s94, 3
    s_lshl_b32 s91, s91, 2
    s_add_u32 s90, s90, s91
    v_add_u32 v6, s90, v34
    s_lshl_b32 s90, s94, 10
    v_add_u32 v7, s90, v33
    ds_read_b128 v[36:39], v7
    ds_read_b32 v40, v6
    s_waitcnt lgkmcnt(0)
    v_mfma_f32_32x32x16_bf16 v[84:99], v[36:39], v[16:19], 0
    s_nop 9
    v_mfma_f32_32x32x8_bf16 v[84:99], v[40:41], v[20:21], v[84:99]
    s_nop 11
    v_max_f32 v100, v100, v84
    v_max_f32 v100, v100, v85
    v_max_f32 v100, v100, v86
    v_max_f32 v100, v100, v87
    v_max_f32 v100, v100, v88
    v_max_f32 v100, v100, v89
    v_max_f32 v100, v100, v90
    v_max_f32 v100, v100, v91
    v_max_f32 v100, v100, v92
    v_max_f32 v100, v100, v93
    v_max_f32 v100, v100, v94
    v_max_f32 v100, v100, v95
    v_max_f32 v100, v100, v96
    v_max_f32 v100, v100, v97
    v_max_f32 v100, v100, v98
    v_max_f32 v100, v100, v99
    s_add_u32 s94, s94, 1
    s_cmp_lt_u32 s94, 64
    s_cbranch_scc1 L_slow1_85
    v_mov_b32 v6, v100
    v_mov_b32 v7, v100
    s_nop 1
    v_permlane32_swap_b32 v6, v7
    v_max_f32 v6, v6, v7
    v_sub_f32 v116, 0, v6
    v_mov_b32 v52, 0
    v_sub_f32 v117, 0, v6
    v_mov_b32 v53, 0
    v_sub_f32 v118, 0, v6
    v_mov_b32 v54, 0
    v_sub_f32 v119, 0, v6
    v_mov_b32 v55, 0
    v_sub_f32 v120, 0, v6
    v_mov_b32 v56, 0
    v_sub_f32 v121, 0, v6
    v_mov_b32 v57, 0
    v_sub_f32 v122, 0, v6
    v_mov_b32 v58, 0
    v_sub_f32 v123, 0, v6
    v_mov_b32 v59, 0
    v_sub_f32 v124, 0, v6
    v_mov_b32 v60, 0
    v_sub_f32 v125, 0, v6
    v_mov_b32 v61, 0
    v_sub_f32 v126, 0, v6
    v_mov_b32 v62, 0
    v_sub_f32 v127, 0, v6
    v_mov_b32 v63, 0
    v_sub_f32 v128, 0, v6
    v_mov_b32 v64, 0
    v_sub_f32 v129, 0, v6
    v_mov_b32 v65, 0
    v_sub_f32 v130, 0, v6
    v_mov_b32 v66, 0
    v_sub_f32 v131, 0, v6
    v_mov_b32 v67, 0
    s_mov_b32 s94, 0
L_slow2_86:
    s_lshr_b32 s90, s94, 2
    s_lshl_b32 s90, s90, 9
    s_and_b32 s91, s94, 3
    s_lshl_b32 s91, s91, 2
    s_add_u32 s90, s90, s91
    v_add_u32 v6, s90, v34
    s_lshl_b32 s90, s94, 10
    v_add_u32 v7, s90, v33
    ds_read_b128 v[36:39], v7
    ds_read_b32 v40, v6
    s_waitcnt lgkmcnt(0)
    v_mfma_f32_32x32x16_bf16 v[84:99], v[36:39], v[16:19], v[116:131]
    s_nop 9
    v_mfma_f32_32x32x8_bf16 v[84:99], v[40:41], v[20:21], v[84:99]
    s_mul_i32 s90, s94, 1280
    v_add_u32 v6, s90, v35
    ds_read_b128 v[44:47], v6
    ds_read_b128 v[48:51], v6 offset:640
    s_nop 7
    v_exp_f32 v84, v84
    v_exp_f32 v85, v85
    v_exp_f32 v86, v86
    v_exp_f32 v87, v87
    v_exp_f32 v88, v88
    v_exp_f32 v89, v89
    v_exp_f32 v90, v90
    v_exp_f32 v91, v91
    v_exp_f32 v92, v92
    v_exp_f32 v93, v93
    v_exp_f32 v94, v94
    v_exp_f32 v95, v95
    v_exp_f32 v96, v96
    v_exp_f32 v97, v97
    v_exp_f32 v98, v98
    v_exp_f32 v99, v99
    s_waitcnt lgkmcnt(0)
    v_smfmac_f32_32x32x32_bf16 v[52:67], v[44:47], v[84:91], v32
    v_smfmac_f32_32x32x32_bf16 v[52:67], v[48:51], v[92:99], v32
    s_add_u32 s94, s94, 1
    s_cmp_lt_u32 s94, 64
    s_cbranch_scc1 L_slow2_86
    s_nop 15
    s_barrier
    s_and_b32 s90, s84, 1
    s_mul_i32 s90, s90, 18
    s_bfe_u32 s91, s84, 0x10001
    s_lshl2_add_u32 s90, s91, s90
    s_mul_i32 s91, s48, 36
    s_add_u32 s90, s90, s91
    s_mul_i32 s64, s90, 1152
    s_mul_i32 s95, s86, 72
    s_add_u32 s64, s64, s95
    s_mul_i32 s65, s84, 82944
    s_add_u32 s65, s65, s95
    s_add_u32 s65, s65, 18432
    s_mul_i32 s66, s48, 13312
    s_sub_u32 s67, 19456, s66
    s_add_u32 s66, s66, 6144
    s_mul_i32 s91, s84, 768
    s_add_u32 m0, s91, 73728
    s_nop 0
    s_mov_b32 exec_hi, 0xffff
    buffer_load_dwordx4 v244, s[44:47], s64 offen lds
    s_mov_b32 exec_hi, -1
    s_nop 0
    s_add_u32 m0, m0, 6144
    s_nop 0
    s_add_u32 s64, s64, 82944
    s_nop 0
    s_mov_b32 exec_hi, 0xffff
    buffer_load_dwordx4 v244, s[44:47], s64 offen lds
    s_mov_b32 exec_hi, -1
    s_nop 0
    s_add_u32 m0, m0, 6144
    s_nop 0
    s_add_u32 s64, s64, 82944
    s_nop 0
    s_mov_b32 exec_hi, 0xffff
    buffer_load_dwordx4 v244, s[44:47], s64 offen lds
    s_mov_b32 exec_hi, -1
    s_nop 0
    s_add_u32 m0, m0, 6144
    s_nop 0
    s_add_u32 s64, s64, 82944
    s_nop 0
    s_mov_b32 exec_hi, 0xffff
    buffer_load_dwordx4 v244, s[44:47], s64 offen lds
    s_mov_b32 exec_hi, -1
    s_nop 0
    s_add_u32 m0, m0, s66
    s_nop 0
    s_add_u32 s64, s64, 82944
    s_nop 0
    s_mov_b32 exec_hi, 0xffff
    buffer_load_dwordx4 v244, s[44:47], s64 offen lds
    s_mov_b32 exec_hi, -1
    s_nop 0
    s_add_u32 m0, m0, s67
    s_nop 0
    s_add_u32 s64, s64, 82944
    s_nop 0
    s_mov_b32 exec_hi, 0xffff
    buffer_load_dwordx4 v244, s[44:47], s64 offen lds
    s_mov_b32 exec_hi, -1
    s_nop 0
    s_add_u32 m0, m0, 6144
    s_nop 0
    s_add_u32 s64, s64, 82944
    s_nop 0
    s_mov_b32 exec_hi, 0xffff
    buffer_load_dwordx4 v244, s[44:47], s64 offen lds
    s_mov_b32 exec_hi, -1
    s_nop 0
    s_add_u32 m0, m0, 6144
    s_nop 0
    s_add_u32 s64, s64, 82944
    s_nop 0
    s_mov_b32 exec_hi, 0xffff
    buffer_load_dwordx4 v244, s[44:47], s64 offen lds
    s_mov_b32 exec_hi, -1
    s_nop 0
    s_add_u32 m0, m0, 6144
    s_nop 0
    s_mov_b32 exec_hi, 0xffff
    buffer_load_dwordx4 v245, s[44:47], s65 offen lds
    s_mov_b32 exec_hi, -1
    s_nop 0
    s_waitcnt vmcnt(0)
    s_barrier
    s_branch L_join
L_end:
    s_endpgm
L_code_end:
.section .rodata,"a"
.p2align 6
.amdhsa_kernel gated_mix__grouped_kv_mqa__moe_arch_mod__prompt_kernel
  .amdhsa_next_free_vgpr 256
  .amdhsa_next_free_sgpr 102
  .amdhsa_accum_offset 256
  .amdhsa_group_segment_fixed_size 0
  .amdhsa_kernarg_size 112
  .amdhsa_user_sgpr_count 2
  .amdhsa_user_sgpr_kernarg_segment_ptr 1
  .amdhsa_system_sgpr_workgroup_id_x 1
.end_amdhsa_kernel
```
